```python
import torch

def _softmax(x, axis=-1):
    return torch.softmax(x, dim=axis)
def _gelu(x):
    return torch.nn.functional.gelu(x, approximate="tanh")
def _silu(x):
    return torch.nn.functional.silu(x)
def _sigmoid(x):
    return torch.sigmoid(x)
def _layernorm(x, axis=-1, eps=1e-5):
    m = x.mean(dim=axis, keepdim=True)
    v = x.var(dim=axis, keepdim=True, unbiased=False)
    return (x - m) / torch.sqrt(v + eps)
def _scatter_add(tgt, idx, src, axis=0):
    return tgt.clone().index_add_(axis, idx, src)
def _segment_sum(src, seg, n):
    out = torch.zeros((n,) + src.shape[1:], dtype=src.dtype)
    return out.index_add_(0, seg, src)
def _pad(x, pw):
    flat = tuple(v for pair in reversed(pw) for v in pair)
    return torch.nn.functional.pad(x, flat)

kernel_name = 'gated_mix__ssm_conv_s5__dense_activation_relu__prompt'

def setup_inputs():

    _w = (lambda a: (lambda t: t.to(torch.bfloat16) if t.is_floating_point() else t)(torch.as_tensor(a)))
    def _A_setup():
        B, S, D = 1, 2048, 512
        P = D
        Lambda_re = -0.5 * (lambda _x: torch.exp(torch.as_tensor(_x)))((lambda *s: torch.randn(*s, dtype=torch.bfloat16) * 0.8)(P))
        Lambda_im = (lambda *s: torch.randn(*s, dtype=torch.bfloat16) * 0.8)(P) * 1.0
        B_re = (lambda *s: torch.randn(*s, dtype=torch.bfloat16) * 0.8)(P, D) * (D ** -0.5)
        B_im = (lambda *s: torch.randn(*s, dtype=torch.bfloat16) * 0.8)(P, D) * (D ** -0.5)
        C_re = (lambda *s: torch.randn(*s, dtype=torch.bfloat16) * 0.8)(D, P) * (P ** -0.5)
        C_im = (lambda *s: torch.randn(*s, dtype=torch.bfloat16) * 0.8)(D, P) * (P ** -0.5)
        log_dt = (lambda *s: torch.randn(*s, dtype=torch.bfloat16) * 0.8)(P) * 0.3 - 2.0
        Dskip = (lambda *s: torch.randn(*s, dtype=torch.bfloat16) * 0.8)(D)
        return {
            "x": _w((lambda *s: torch.randn(*s, dtype=torch.bfloat16) * 0.05)(B, S, D)),
            "Lambda_re": _w(Lambda_re),
            "Lambda_im": _w(Lambda_im),
            "B_re": _w(B_re),
            "B_im": _w(B_im),
            "C_re": _w(C_re),
            "C_im": _w(C_im),
            "log_dt": _w(log_dt),
            "Dskip": _w(Dskip),
        }
    _A_in = _A_setup()

    def _B_setup():
        B, S, D, Dff = 1, 2048, 512, 1792
        return {
            "x": _w((lambda *s: torch.randn(*s, dtype=torch.bfloat16) * 0.05)(B, S, D)),
            "w1": _w((lambda *s: torch.randn(*s, dtype=torch.bfloat16) * 0.05)(D, Dff)),
            "w2": _w((lambda *s: torch.randn(*s, dtype=torch.bfloat16) * 0.05)(Dff, D)),
        }
    _B_in = _B_setup()

    return {
        "A_x": _A_in["x"],
        "A_Lambda_re": _A_in["Lambda_re"],
        "A_Lambda_im": _A_in["Lambda_im"],
        "A_B_re": _A_in["B_re"],
        "A_B_im": _A_in["B_im"],
        "A_C_re": _A_in["C_re"],
        "A_C_im": _A_in["C_im"],
        "A_log_dt": _A_in["log_dt"],
        "A_Dskip": _A_in["Dskip"],
        "B_x": _B_in["x"],
        "B_w1": _B_in["w1"],
        "B_w2": _B_in["w2"],
        "gate_w": _w((lambda *s: torch.randn(*s, dtype=torch.bfloat16) * 0.05)(512) * 16.0),
    }

def reference(A_x, A_Lambda_re, A_Lambda_im, A_B_re, A_B_im, A_C_re, A_C_im, A_log_dt, A_Dskip, B_x, B_w1, B_w2, gate_w):
    def _A_ref(x, Lambda_re, Lambda_im, B_re, B_im, C_re, C_im, log_dt, Dskip):
        Bsz, L, H = x.shape
        Lam = Lambda_re + 1j * Lambda_im
        Bmat = B_re + 1j * B_im
        Cmat = C_re + 1j * C_im
        dt = torch.exp(log_dt)
        Lam_bar = torch.exp(dt * Lam)
        B_bar = ((Lam_bar - 1.0) / Lam)[:, None] * Bmat
        Bu = torch.einsum("bld,pd->blp", x + 0j, B_bar)
        h = torch.zeros_like(Bu[:, 0, :])
        hs = []
        for t in range(L):
            h = Lam_bar[None, :] * h + Bu[:, t, :]
            hs.append(h)
        hseq = torch.stack(hs, 1)
        y = 2.0 * torch.einsum("blp,dp->bld", hseq, Cmat).real + x * Dskip[None, None, :]
        return y

    def _B_ref(x, w1, w2):
        h = torch.einsum("bsd,df->bsf", x, w1)
        zero = torch.zeros_like(h)
        h = torch.maximum(h, zero)
        return torch.einsum("bsf,fd->bsd", h, w2)

    x = A_x
    g = _sigmoid((x * gate_w).sum(-1, keepdims=True))
    a = _A_ref(x, A_Lambda_re, A_Lambda_im, A_B_re, A_B_im, A_C_re, A_C_im, A_log_dt, A_Dskip)
    b = _B_ref(x, B_w1, B_w2)
    return g * a + (1 - g) * b
```

```asm
; @launch grid=(256,1,1) block=(256,1,1) lds=157696
.amdgcn_target "amdgcn-amd-amdhsa--gfx950"
.text
.globl gated_mix__ssm_conv_s5__dense_activation_relu__prompt_kernel
.p2align 8
.type gated_mix__ssm_conv_s5__dense_activation_relu__prompt_kernel,@function
gated_mix__ssm_conv_s5__dense_activation_relu__prompt_kernel:
s_cmp_ge_u32 s2, 256
s_cbranch_scc1 L_end
s_load_dwordx16 s[16:31], s[0:1], 0
s_load_dwordx16 s[32:47], s[0:1], 64
s_getpc_b64 s[12:13]
L_pc:
s_bfe_u32 s3, s2, 0x30003
v_lshrrev_b32 v1, 6, v0
v_and_b32 v2, 63, v0
v_lshlrev_b32 v2, 2, v2
v_add_u32 v1, v1, v2
v_lshl_add_u32 v1, v1, 3, s3
v_cmp_gt_u32 vcc, (L_end - L_pc) / 128 + 1, v1
v_lshlrev_b32 v1, 7, v1
s_nop 0
s_mov_b64 exec, vcc
global_load_dword v241, v1, s[12:13]
s_mov_b64 exec, -1
s_memrealtime s[100:101]
v_lshrrev_b32 v1, 6, v0
v_and_b32 v0, 63, v0
v_readfirstlane_b32 s3, v1
s_and_b32 s9, s2, 7
s_lshr_b32 s93, s2, 3
s_and_b32 s7, s93, 7
s_lshr_b32 s94, s93, 3
s_lshl_b32 s6, s9, 2
s_add_u32 s6, s6, s94
s_and_b32 s4, s9, 1
s_lshl_b32 s4, s4, 3
s_add_u32 s4, s4, s7
s_lshr_b32 s92, s9, 1
s_lshl_b32 s5, s92, 2
s_add_u32 s5, s5, s94
s_mul_i32 s92, s92, 7
s_lshl_b32 s97, s94, 1
s_add_u32 s97, s97, s92
s_lshl_b32 s88, s4, 2
s_add_u32 s88, s88, s3
s_lshl_b32 s88, s88, 15
s_lshl_b32 s90, s3, 14
s_lshl_b32 s99, s3, 11
s_lshl_b32 s92, s97, 7
s_mul_i32 s89, s3, 57344
s_add_u32 s89, s89, s92
v_lshrrev_b32 v1, 4, v0
v_and_b32 v12, 7, v0
v_xor_b32 v2, v12, v1
v_lshlrev_b32 v2, 4, v2
v_lshrrev_b32 v3, 5, v0
v_lshlrev_b32 v3, 14, v3
v_bfe_u32 v4, v0, 3, 2
v_lshl_add_u32 v3, v4, 10, v3
v_add_u32 v4, v3, v2
v_xor_b32 v8, 64, v2
v_add_u32 v5, v3, v8
v_add_u32 v5, 3072, v5
v_add_u32 v6, 6144, v4
v_add_u32 v7, 6144, v5
v_lshrrev_b32 v30, 3, v0
v_mul_u32_u24 v9, 3584, v30
v_and_b32 v1, 1, v1
v_lshlrev_b32 v1, 2, v1
v_xor_b32 v12, v12, v1
v_lshl_add_u32 v9, v12, 4, v9
v_add_u32 v10, 27648, v9
s_mov_b32 s91, s7
s_add_u32 s91, s91, s9
s_and_b32 s91, s91, 7
s_mov_b32 s50, 0x200000
s_mov_b32 s51, 0x20000
s_mov_b32 s54, 0x1c0000
s_mov_b32 s55, 0x20000
s_waitcnt lgkmcnt(0)
s_mov_b32 s48, s16
s_mov_b32 s49, s17
s_mov_b32 s52, s36
s_mov_b32 s53, s37
s_mov_b32 s101, s91
s_add_u32 m0, s90, 65536
s_lshl_b32 s12, s91, 7
s_add_u32 s12, s12, s88
s_add_u32 s91, s91, 1
s_and_b32 s91, s91, 7
buffer_load_dwordx4 v4, s[48:51], s12 offen offset:0 lds
buffer_load_dwordx4 v5, s[48:51], s12 offen offset:1024 lds
buffer_load_dwordx4 v6, s[48:51], s12 offen offset:2048 lds
buffer_load_dwordx4 v7, s[48:51], s12 offen offset:3072 lds
s_add_u32 m0, s99, 0
s_add_u32 s13, s101, 0
s_and_b32 s13, s13, 7
s_mul_i32 s13, s13, 229376
s_add_u32 s13, s13, s89
buffer_load_dwordx4 v9, s[52:55], s13 offen offset:0 lds
buffer_load_dwordx4 v10, s[52:55], s13 offen offset:1024 lds
s_add_u32 m0, s90, 69632
s_lshl_b32 s12, s91, 7
s_add_u32 s12, s12, s88
s_add_u32 s91, s91, 1
s_and_b32 s91, s91, 7
buffer_load_dwordx4 v4, s[48:51], s12 offen offset:0 lds
buffer_load_dwordx4 v5, s[48:51], s12 offen offset:1024 lds
buffer_load_dwordx4 v6, s[48:51], s12 offen offset:2048 lds
buffer_load_dwordx4 v7, s[48:51], s12 offen offset:3072 lds
s_add_u32 m0, s99, 8192
s_add_u32 s13, s101, 1
s_and_b32 s13, s13, 7
s_mul_i32 s13, s13, 229376
s_add_u32 s13, s13, s89
buffer_load_dwordx4 v9, s[52:55], s13 offen offset:0 lds
buffer_load_dwordx4 v10, s[52:55], s13 offen offset:1024 lds
v_and_b32 v29, 31, v0
v_lshl_add_u32 v3, s5, 5, v29
v_lshlrev_b32 v3, 1, v3
global_load_ushort v142, v3, s[18:19]
global_load_ushort v143, v3, s[20:21]
global_load_ushort v144, v3, s[30:31]
s_or_b32 s100, s100, 1
s_or_b32 s92, s2, s3
s_cmp_lg_u32 s92, 0
s_cbranch_scc1 L_nononce
v_mov_b32 v1, s100
v_mov_b32 v3, 0
s_mov_b64 exec, 1
global_store_dword v3, v1, s[44:45] sc1
s_mov_b64 exec, -1
L_nononce:
s_lshl_b32 s92, s3, 13
s_and_b32 s93, s3, 1
s_lshl_b32 s93, s93, 6
v_xor_b32 v8, s93, v2
v_lshl_add_u32 v8, v30, 10, v8
v_add_u32 v8, s92, v8
s_lshl_b32 s21, s5, 15
s_lshl_b32 s20, s3, 10
s_mov_b32 s8, s101
v_and_b32 v1, 1, v30
v_cmp_eq_u32 vcc, v1, v12
v_and_b32 v1, 6, v30
v_lshlrev_b32 v1, 1, v1
v_mov_b32 v3, 0x40000000
v_cndmask_b32 v1, v3, v1, vcc
s_cmp_eq_u32 s94, 3
s_cselect_b64 vcc, -1, 0
v_add_u32 v11, 128, v9
v_add_u32 v12, 128, v10
v_add_u32 v3, 1024, v1
v_add_u32 v1, 16, v1
v_cndmask_b32 v11, v11, v3, vcc
v_cndmask_b32 v12, v12, v1, vcc
s_sub_u32 s40, s40, 1024
s_subb_u32 s41, s41, 0
s_mov_b32 s80, s42
s_mov_b32 s81, s43
s_mov_b32 s82, 0x400000
s_mov_b32 s83, 0x20000
s_mov_b32 s56, s22
s_mov_b32 s57, s23
s_mov_b32 s58, 0x80000
s_mov_b32 s59, 0x20000
s_add_u32 m0, s90, 73728
s_lshl_b32 s12, s91, 7
s_add_u32 s12, s12, s88
s_add_u32 s91, s91, 1
s_and_b32 s91, s91, 7
buffer_load_dwordx4 v4, s[48:51], s12 offen offset:0 lds
s_mov_b32 s60, s24
s_mov_b32 s61, s25
s_mov_b32 s62, 0x80000
s_mov_b32 s63, 0x20000
s_mov_b32 s68, s26
s_mov_b32 s69, s27
s_mov_b32 s70, 0x80000
s_mov_b32 s71, 0x20000
buffer_load_dwordx4 v5, s[48:51], s12 offen offset:1024 lds
s_mov_b32 s72, s28
s_mov_b32 s73, s29
s_mov_b32 s74, 0x80000
s_mov_b32 s75, 0x20000
s_mov_b32 s30, 229376
s_mov_b32 s95, 8192
s_cmp_eq_u32 s94, 3
s_cselect_b32 s24, s40, s36
s_cselect_b32 s25, s41, s37
s_cselect_b32 s26, 0x800, s54
s_mov_b32 s27, 0x20000
s_cselect_b32 s30, 128, s30
s_cselect_b32 s95, 0x40000000, s95
s_mov_b32 s64, s38
s_mov_b32 s65, s39
s_mov_b32 s66, 0x1c0000
s_mov_b32 s67, 0x20000
buffer_load_dwordx4 v6, s[48:51], s12 offen offset:2048 lds
s_mov_b32 s76, s46
s_mov_b32 s77, s47
s_mov_b32 s78, 0xdd0000
s_mov_b32 s79, 0x20000
s_mov_b32 s92, 1024
v_and_b32 v31, 7, v0
v_lshlrev_b32 v31, 4, v31
v_lshrrev_b32 v1, 3, v0
v_mad_u32_u24 v31, v1, s92, v31
v_add_u32 v25, s95, v31
v_lshrrev_b32 v1, 5, v0
v_bfe_u32 v2, v0, 1, 3
v_xor_b32 v2, v2, v1
v_lshlrev_b32 v2, 4, v2
buffer_load_dwordx4 v7, s[48:51], s12 offen offset:3072 lds
v_lshl_add_u32 v17, v29, 7, v2
v_xor_b32 v18, 32, v17
v_xor_b32 v19, 64, v17
v_xor_b32 v20, 96, v17
s_add_u32 s92, s90, 65536
v_add_u32 v13, s92, v17
v_add_u32 v14, s92, v18
v_add_u32 v15, s92, v19
v_add_u32 v16, s92, v20
v_bfe_u32 v2, v0, 2, 2
v_lshl_add_u32 v3, v1, 3, v2
v_lshl_add_u32 v1, v1, 2, v2
v_bfe_u32 v2, v0, 3, 1
v_lshlrev_b32 v2, 6, v2
s_add_u32 m0, s99, 16384
s_add_u32 s13, s101, 2
s_and_b32 s13, s13, 7
s_mul_i32 s13, s13, 229376
s_add_u32 s13, s13, s89
buffer_load_dwordx4 v9, s[52:55], s13 offen offset:0 lds
v_bfe_u32 v21, v0, 4, 1
v_lshl_add_u32 v2, v21, 5, v2
v_and_b32 v21, 3, v0
v_lshl_add_u32 v2, v21, 3, v2
v_lshl_add_u32 v21, v3, 7, v2
v_xor_b32 v22, 64, v21
s_and_b32 s92, s3, 1
s_lshl_b32 s92, s92, 6
v_lshl_add_u32 v1, v1, 7, v2
v_xor_b32 v1, s92, v1
s_lshl_b32 s93, s3, 13
v_add_u32 v29, s93, v1
v_xor_b32 v30, 64, v29
buffer_load_dwordx4 v10, s[52:55], s13 offen offset:1024 lds
s_add_u32 s93, s93, 0x10000
v_add_u32 v23, s93, v29
v_add_u32 v24, s93, v30
s_lshl_b32 s92, s3, 9
s_add_u32 s92, s92, 131072
v_lshl_add_u32 v1, v0, 3, s92
v_mov_b32 v2, 0
v_mov_b32 v3, 0
ds_write_b64 v1, v[2:3]
s_lshl_b32 s92, s5, 13
s_sub_u32 s93, 16, s4
s_lshl_b32 s93, s93, 9
s_add_u32 s92, s92, s93
s_add_u32 s92, s92, 0xd60000
s_add_u32 s84, s46, s92
s_addc_u32 s85, s47, 0
s_add_u32 m0, s90, 77824
s_lshl_b32 s12, s91, 7
s_add_u32 s12, s12, s88
s_add_u32 s91, s91, 1
s_and_b32 s91, s91, 7
buffer_load_dwordx4 v4, s[48:51], s12 offen offset:0 lds
s_lshl_b32 s86, s4, 9
s_mov_b32 s87, 0x20000
s_mul_i32 s95, s3, 7
s_lshr_b32 s94, s2, 6
s_add_u32 s94, s94, s7
s_and_b32 s94, s94, 3
buffer_load_dwordx4 v5, s[48:51], s12 offen offset:1024 lds
s_mov_b32 s92, 0
s_cmp_eq_u32 s94, 0
s_cselect_b32 s92, 1, s92
s_add_u32 s92, s92, s9
s_and_b32 s92, s92, 3
s_lshl_b32 s92, s92, 1
s_add_u32 s34, s92, s95
s_mov_b32 s92, 1
s_cmp_eq_u32 s94, 1
s_cselect_b32 s92, 2, s92
s_cmp_eq_u32 s94, 0
s_cselect_b32 s92, 0, s92
s_add_u32 s92, s92, s9
s_and_b32 s92, s92, 3
s_lshl_b32 s92, s92, 1
s_add_u32 s35, s92, s95
buffer_load_dwordx4 v6, s[48:51], s12 offen offset:2048 lds
s_mov_b32 s92, 2
s_cmp_eq_u32 s94, 2
s_cselect_b32 s92, 3, s92
s_cmp_eq_u32 s94, 1
s_cselect_b32 s92, 1, s92
s_add_u32 s92, s92, s9
s_and_b32 s92, s92, 3
s_lshl_b32 s92, s92, 1
s_add_u32 s36, s92, s95
s_mov_b32 s92, 3
s_cmp_eq_u32 s94, 2
s_cselect_b32 s92, 2, s92
s_add_u32 s92, s92, s9
s_and_b32 s92, s92, 3
s_lshl_b32 s92, s92, 1
s_add_u32 s37, s92, s95
s_mul_i32 s93, s9, 43
s_lshr_b32 s93, s93, 7
s_mul_i32 s93, s93, 3
s_sub_u32 s93, s9, s93
s_add_u32 s95, s95, 1
buffer_load_dwordx4 v7, s[48:51], s12 offen offset:3072 lds
s_mov_b32 s92, 0
s_cmp_eq_u32 s94, 0
s_cselect_b32 s92, 1, s92
s_add_u32 s92, s92, s93
s_sub_u32 s98, s92, 3
s_cmp_ge_u32 s92, 3
s_cselect_b32 s92, s98, s92
s_lshl_b32 s92, s92, 1
s_add_u32 s38, s92, s95
s_mov_b32 s92, 1
s_cmp_eq_u32 s94, 1
s_cselect_b32 s92, 2, s92
s_cmp_eq_u32 s94, 0
s_cselect_b32 s92, 0, s92
s_add_u32 s92, s92, s93
s_sub_u32 s98, s92, 3
s_cmp_ge_u32 s92, 3
s_cselect_b32 s92, s98, s92
s_lshl_b32 s92, s92, 1
s_add_u32 s39, s92, s95
s_add_u32 m0, s99, 24576
s_add_u32 s13, s101, 3
s_and_b32 s13, s13, 7
s_mul_i32 s13, s13, 229376
s_add_u32 s13, s13, s89
buffer_load_dwordx4 v9, s[52:55], s13 offen offset:0 lds
s_mov_b32 s92, 2
s_cmp_eq_u32 s94, 1
s_cselect_b32 s92, 1, s92
s_add_u32 s92, s92, s93
s_sub_u32 s98, s92, 3
s_cmp_ge_u32 s92, 3
s_cselect_b32 s92, s98, s92
s_lshl_b32 s92, s92, 1
s_add_u32 s47, s92, s95
buffer_load_dwordx4 v10, s[52:55], s13 offen offset:1024 lds
s_sub_u32 s94, 3, s94
s_mov_b32 s92, 0
s_cmp_eq_u32 s94, 0
s_cselect_b32 s92, 1, s92
s_add_u32 s92, s92, s9
s_and_b32 s18, s92, 3
s_mov_b32 s92, 1
s_cmp_eq_u32 s94, 1
s_cselect_b32 s92, 2, s92
s_cmp_eq_u32 s94, 0
s_cselect_b32 s92, 0, s92
s_add_u32 s92, s92, s9
s_and_b32 s19, s92, 3
s_add_u32 m0, s99, 32768
s_add_u32 s13, s101, 4
s_and_b32 s13, s13, 7
s_mul_i32 s13, s13, 229376
s_add_u32 s13, s13, s89
buffer_load_dwordx4 v9, s[52:55], s13 offen offset:0 lds
s_mov_b32 s92, 2
s_cmp_eq_u32 s94, 2
s_cselect_b32 s92, 3, s92
s_cmp_eq_u32 s94, 1
s_cselect_b32 s92, 1, s92
s_add_u32 s92, s92, s9
s_and_b32 s40, s92, 3
s_mov_b32 s92, 3
s_cmp_eq_u32 s94, 2
s_cselect_b32 s92, 2, s92
s_add_u32 s92, s92, s9
s_and_b32 s41, s92, 3
buffer_load_dwordx4 v10, s[52:55], s13 offen offset:1024 lds
s_lshr_b32 s92, s88, 16
s_mul_i32 s96, s92, 360448
s_and_b32 s92, s3, 1
s_lshl_b32 s92, s92, 9
s_add_u32 s96, s96, s92
s_mul_i32 s97, s97, 8192
s_add_u32 s97, s97, s96
s_lshl_b32 s46, s3, 13
s_lshr_b32 s92, s2, 6
s_lshl_b32 s92, s92, 14
v_and_b32 v240, 15, v0
v_lshlrev_b32 v240, 10, v240
v_add_u32 v240, s92, v240
s_add_u32 m0, s99, 40960
s_add_u32 s13, s101, 5
s_and_b32 s13, s13, 7
s_mul_i32 s13, s13, 229376
s_add_u32 s13, s13, s89
buffer_load_dwordx4 v9, s[52:55], s13 offen offset:0 lds
s_waitcnt vmcnt(24) lgkmcnt(0)
s_barrier
ds_read_b128 a[0:3], v13 offset:0
ds_read_b64_tr_b16 a[128:129], v21 offset:0
ds_read_b64_tr_b16 a[130:131], v21 offset:512
ds_read_b64_tr_b16 a[132:133], v22 offset:0
ds_read_b64_tr_b16 a[134:135], v22 offset:512
ds_read_b128 a[4:7], v14 offset:0
ds_read_b64_tr_b16 a[136:137], v21 offset:2048
ds_read_b64_tr_b16 a[138:139], v21 offset:2560
ds_read_b64_tr_b16 a[140:141], v22 offset:2048
ds_read_b64_tr_b16 a[142:143], v22 offset:2560
ds_read_b128 a[8:11], v15 offset:0
buffer_load_dwordx4 v10, s[52:55], s13 offen offset:1024 lds
ds_read_b64_tr_b16 a[144:145], v21 offset:4096
ds_read_b64_tr_b16 a[146:147], v21 offset:4608
ds_read_b64_tr_b16 a[148:149], v22 offset:4096
ds_read_b64_tr_b16 a[150:151], v22 offset:4608
s_waitcnt lgkmcnt(10)
v_mfma_f32_32x32x16_bf16 v[64:79], a[128:131], a[0:3], 0
ds_read_b128 a[12:15], v16 offset:0
ds_read_b64_tr_b16 a[152:153], v21 offset:6144
ds_read_b64_tr_b16 a[154:155], v21 offset:6656
v_mfma_f32_32x32x16_bf16 v[80:95], a[132:135], a[0:3], 0
ds_read_b64_tr_b16 a[156:157], v22 offset:6144
ds_read_b64_tr_b16 a[158:159], v22 offset:6656
s_add_u32 m0, s99, 49152
s_add_u32 s13, s101, 6
s_and_b32 s13, s13, 7
s_mul_i32 s13, s13, 229376
s_add_u32 s13, s13, s89
buffer_load_dwordx4 v9, s[52:55], s13 offen offset:0 lds
s_waitcnt lgkmcnt(10)
v_mfma_f32_32x32x16_bf16 v[64:79], a[136:139], a[4:7], v[64:79]
s_waitcnt vmcnt(20)
s_barrier
s_lshl_b32 s92, s2, 2
s_add_u32 s92, s92, s3
s_cmp_ge_u32 s92, 1024
s_cbranch_scc1 L_nomw1
s_mov_b32 s42, s56
s_mov_b32 s43, s57
s_mov_b32 s93, s92
s_sub_u32 s98, s92, 256
s_cmp_ge_u32 s92, 256
s_cselect_b32 s42, s60, s42
s_cselect_b32 s43, s61, s43
s_cselect_b32 s93, s98, s93
s_sub_u32 s98, s92, 512
s_cmp_ge_u32 s92, 512
s_cselect_b32 s42, s68, s42
s_cselect_b32 s43, s69, s43
s_cselect_b32 s93, s98, s93
s_sub_u32 s98, s92, 768
s_cmp_ge_u32 s92, 768
s_cselect_b32 s42, s72, s42
s_cselect_b32 s43, s73, s43
s_cselect_b32 s93, s98, s93
s_mul_i32 s93, s93, 2048
v_lshl_add_u32 v242, v0, 7, s93
s_mov_b64 exec, 0xffff
global_load_dword v241, v242, s[42:43]
s_mov_b64 exec, -1
L_nomw1:
ds_read_b128 a[16:19], v13 offset:4096
buffer_load_dwordx4 v10, s[52:55], s13 offen offset:1024 lds
s_add_u32 m0, s99, 57344
s_add_u32 s13, s101, 7
s_and_b32 s13, s13, 7
s_mul_i32 s13, s13, 229376
s_add_u32 s13, s13, s89
buffer_load_dwordx4 v9, s[52:55], s13 offen offset:0 lds
ds_read_b64_tr_b16 a[128:129], v21 offset:8192
ds_read_b64_tr_b16 a[130:131], v21 offset:8704
v_mfma_f32_32x32x16_bf16 v[80:95], a[140:143], a[4:7], v[80:95]
ds_read_b64_tr_b16 a[132:133], v22 offset:8192
ds_read_b64_tr_b16 a[134:135], v22 offset:8704
s_waitcnt lgkmcnt(10)
v_mfma_f32_32x32x16_bf16 v[64:79], a[144:147], a[8:11], v[64:79]
buffer_load_dwordx4 v10, s[52:55], s13 offen offset:1024 lds
ds_read_b128 a[20:23], v14 offset:4096
ds_read_b64_tr_b16 a[136:137], v21 offset:10240
ds_read_b64_tr_b16 a[138:139], v21 offset:10752
s_waitcnt vmcnt(20)
v_lshlrev_b32 v142, 16, v142
v_mfma_f32_32x32x16_bf16 v[80:95], a[148:151], a[8:11], v[80:95]
ds_read_b64_tr_b16 a[140:141], v22 offset:10240
ds_read_b64_tr_b16 a[142:143], v22 offset:10752
v_lshlrev_b32 v143, 16, v143
v_lshlrev_b32 v144, 16, v144
v_mul_f32 v144, 0x3fb8aa3b, v144
s_waitcnt lgkmcnt(10)
v_mfma_f32_32x32x16_bf16 v[64:79], a[152:155], a[12:15], v[64:79]
s_add_u32 m0, s90, 65536
s_lshl_b32 s12, s91, 7
s_add_u32 s12, s12, s88
s_add_u32 s91, s91, 1
s_and_b32 s91, s91, 7
buffer_load_dwordx4 v4, s[48:51], s12 offen offset:0 lds
ds_read_b128 a[24:27], v15 offset:4096
ds_read_b64_tr_b16 a[144:145], v21 offset:12288
ds_read_b64_tr_b16 a[146:147], v21 offset:12800
v_exp_f32 v144, v144
s_nop 0
v_cvt_pk_bf16_f32 v144, v144, v144
v_mfma_f32_32x32x16_bf16 v[80:95], a[156:159], a[12:15], v[80:95]
ds_read_b64_tr_b16 a[148:149], v22 offset:12288
buffer_load_dwordx4 v5, s[48:51], s12 offen offset:1024 lds
ds_read_b64_tr_b16 a[150:151], v22 offset:12800
v_lshlrev_b32 v144, 16, v144
v_mul_f32 v145, v144, v142
v_mul_f32 v146, v144, v143
s_waitcnt lgkmcnt(10)
v_mfma_f32_32x32x16_bf16 v[64:79], a[128:131], a[16:19], v[64:79]
ds_read_b128 a[28:31], v16 offset:4096
ds_read_b64_tr_b16 a[152:153], v21 offset:14336
ds_read_b64_tr_b16 a[154:155], v21 offset:14848
v_mul_f32 v145, 0x3fb8aa3b, v145
v_exp_f32 v145, v145
v_mfma_f32_32x32x16_bf16 v[80:95], a[132:135], a[16:19], v[80:95]
ds_read_b64_tr_b16 a[156:157], v22 offset:14336
ds_read_b64_tr_b16 a[158:159], v22 offset:14848
buffer_load_dwordx4 v6, s[48:51], s12 offen offset:2048 lds
v_mul_f32 v146, 0.15915494, v146
v_rndne_f32 v147, v146
v_sub_f32 v146, v146, v147
s_waitcnt lgkmcnt(10)
v_mfma_f32_32x32x16_bf16 v[64:79], a[136:139], a[20:23], v[64:79]
s_waitcnt vmcnt(17)
s_barrier
ds_read_b128 a[32:35], v13 offset:8192
ds_read_b64_tr_b16 a[128:129], v21 offset:16384
ds_read_b64_tr_b16 a[130:131], v21 offset:16896
v_cos_f32 v147, v146
v_sin_f32 v148, v146
v_mfma_f32_32x32x16_bf16 v[80:95], a[140:143], a[20:23], v[80:95]
ds_read_b64_tr_b16 a[132:133], v22 offset:16384
buffer_load_dwordx4 v7, s[48:51], s12 offen offset:3072 lds
ds_read_b64_tr_b16 a[134:135], v22 offset:16896
v_mul_f32 v128, v145, v147
v_mul_f32 v129, v145, v148
v_add_f32 v144, -1.0, v128
s_waitcnt lgkmcnt(10)
v_mfma_f32_32x32x16_bf16 v[64:79], a[144:147], a[24:27], v[64:79]
ds_read_b128 a[36:39], v14 offset:8192
ds_read_b64_tr_b16 a[136:137], v21 offset:18432
ds_read_b64_tr_b16 a[138:139], v21 offset:18944
v_mul_f32 v145, v142, v142
v_fmac_f32 v145, v143, v143
v_mfma_f32_32x32x16_bf16 v[80:95], a[148:151], a[24:27], v[80:95]
ds_read_b64_tr_b16 a[140:141], v22 offset:18432
s_add_u32 m0, s20, 0
s_lshl_b32 s12, s8, 7
s_add_u32 s12, s12, s21
s_add_u32 s8, s8, 1
s_and_b32 s8, s8, 7
buffer_load_dwordx4 v8, s[56:59], s12 offen offset:0 lds
ds_read_b64_tr_b16 a[142:143], v22 offset:18944
v_rcp_f32 v145, v145
v_mul_f32 v146, v144, v142
v_add_f32 v145, v145, v145
s_waitcnt lgkmcnt(10)
v_mfma_f32_32x32x16_bf16 v[64:79], a[152:155], a[28:31], v[64:79]
ds_read_b128 a[40:43], v15 offset:8192
ds_read_b64_tr_b16 a[144:145], v21 offset:20480
ds_read_b64_tr_b16 a[146:147], v21 offset:20992
v_fmac_f32 v146, v129, v143
s_add_u32 m0, s20, 4096
s_nop 0
buffer_load_dwordx4 v8, s[60:63], s12 offen offset:0 lds
v_mul_f32 v138, v146, v145
v_mfma_f32_32x32x16_bf16 v[80:95], a[156:159], a[28:31], v[80:95]
ds_read_b64_tr_b16 a[148:149], v22 offset:20480
ds_read_b64_tr_b16 a[150:151], v22 offset:20992
v_mul_f32 v147, v129, v142
v_fma_f32 v147, -v144, v143, v147
v_mul_f32 v139, v147, v145
s_waitcnt lgkmcnt(10)
v_mfma_f32_32x32x16_bf16 v[64:79], a[128:131], a[32:35], v[64:79]
ds_read_b128 a[44:47], v16 offset:8192
ds_read_b64_tr_b16 a[152:153], v21 offset:22528
ds_read_b64_tr_b16 a[154:155], v21 offset:23040
s_add_u32 m0, s90, 69632
s_lshl_b32 s12, s91, 7
s_add_u32 s12, s12, s88
s_add_u32 s91, s91, 1
s_and_b32 s91, s91, 7
buffer_load_dwordx4 v4, s[48:51], s12 offen offset:0 lds
v_mul_f32 v142, v128, v128
v_mul_f32 v143, v128, v129
v_mfma_f32_32x32x16_bf16 v[80:95], a[132:135], a[32:35], v[80:95]
ds_read_b64_tr_b16 a[156:157], v22 offset:22528
ds_read_b64_tr_b16 a[158:159], v22 offset:23040
v_fma_f32 v142, -v129, v129, v142
v_add_f32 v143, v143, v143
v_mul_f32 v144, v142, v142
s_waitcnt lgkmcnt(10)
v_mfma_f32_32x32x16_bf16 v[64:79], a[136:139], a[36:39], v[64:79]
buffer_load_dwordx4 v5, s[48:51], s12 offen offset:1024 lds
s_waitcnt vmcnt(16)
s_barrier
s_lshl_b32 s92, s2, 2
s_add_u32 s92, s92, s3
s_cmp_ge_u32 s92, 896
s_cbranch_scc1 L_nomw2
s_mov_b32 s42, s64
s_mov_b32 s43, s65
s_mov_b32 s93, s92
s_mul_i32 s93, s93, 2048
v_lshl_add_u32 v242, v0, 7, s93
s_mov_b64 exec, 0xffff
global_load_dword v241, v242, s[42:43]
s_mov_b64 exec, -1
L_nomw2:
ds_read_b128 a[48:51], v13 offset:12288
ds_read_b64_tr_b16 a[128:129], v21 offset:24576
ds_read_b64_tr_b16 a[130:131], v21 offset:25088
buffer_load_dwordx4 v6, s[48:51], s12 offen offset:2048 lds
v_mul_f32 v145, v142, v143
v_fma_f32 v144, -v143, v143, v144
v_mfma_f32_32x32x16_bf16 v[80:95], a[140:143], a[36:39], v[80:95]
ds_read_b64_tr_b16 a[132:133], v22 offset:24576
ds_read_b64_tr_b16 a[134:135], v22 offset:25088
v_add_f32 v145, v145, v145
v_mul_f32 v142, v144, v144
v_mul_f32 v143, v144, v145
s_waitcnt lgkmcnt(10)
v_mfma_f32_32x32x16_bf16 v[64:79], a[144:147], a[40:43], v[64:79]
ds_read_b128 a[52:55], v14 offset:12288
ds_read_b64_tr_b16 a[136:137], v21 offset:26624
ds_read_b64_tr_b16 a[138:139], v21 offset:27136
v_fma_f32 v142, -v145, v145, v142
buffer_load_dwordx4 v7, s[48:51], s12 offen offset:3072 lds
v_add_f32 v143, v143, v143
v_mfma_f32_32x32x16_bf16 v[80:95], a[148:151], a[40:43], v[80:95]
ds_read_b64_tr_b16 a[140:141], v22 offset:26624
ds_read_b64_tr_b16 a[142:143], v22 offset:27136
v_mul_f32 v130, v142, v142
v_mul_f32 v131, v142, v143
v_fma_f32 v130, -v143, v143, v130
s_waitcnt lgkmcnt(10)
v_mfma_f32_32x32x16_bf16 v[64:79], a[152:155], a[44:47], v[64:79]
ds_read_b128 a[56:59], v15 offset:12288
ds_read_b64_tr_b16 a[144:145], v21 offset:28672
ds_read_b64_tr_b16 a[146:147], v21 offset:29184
v_add_f32 v131, v131, v131
s_add_u32 m0, s90, 73728
s_lshl_b32 s12, s91, 7
s_add_u32 s12, s12, s88
s_add_u32 s91, s91, 1
s_and_b32 s91, s91, 7
buffer_load_dwordx4 v4, s[48:51], s12 offen offset:0 lds
v_mul_f32 v142, v130, v130
v_mfma_f32_32x32x16_bf16 v[80:95], a[156:159], a[44:47], v[80:95]
ds_read_b64_tr_b16 a[148:149], v22 offset:28672
ds_read_b64_tr_b16 a[150:151], v22 offset:29184
v_mul_f32 v143, v130, v131
v_fma_f32 v142, -v131, v131, v142
v_add_f32 v143, v143, v143
s_waitcnt lgkmcnt(10)
v_mfma_f32_32x32x16_bf16 v[64:79], a[128:131], a[48:51], v[64:79]
ds_read_b128 a[60:63], v16 offset:12288
buffer_load_dwordx4 v5, s[48:51], s12 offen offset:1024 lds
ds_read_b64_tr_b16 a[152:153], v21 offset:30720
ds_read_b64_tr_b16 a[154:155], v21 offset:31232
v_cmp_lt_u32 vcc, 31, v0
s_nop 1
v_cndmask_b32 v146, 1.0, v130, vcc
v_mfma_f32_32x32x16_bf16 v[80:95], a[132:135], a[48:51], v[80:95]
ds_read_b64_tr_b16 a[156:157], v22 offset:30720
ds_read_b64_tr_b16 a[158:159], v22 offset:31232
v_cndmask_b32 v147, 0, v131, vcc
v_mul_f32 v144, v142, v142
v_mul_f32 v145, v142, v143
s_waitcnt lgkmcnt(10)
v_mfma_f32_32x32x16_bf16 v[64:79], a[136:139], a[52:55], v[64:79]
s_waitcnt vmcnt(8)
s_barrier
ds_read_b128 a[64:67], v13 offset:0
buffer_load_dwordx4 v6, s[48:51], s12 offen offset:2048 lds
ds_read_b64_tr_b16 a[128:129], v21 offset:32768
ds_read_b64_tr_b16 a[130:131], v21 offset:33280
v_fma_f32 v144, -v143, v143, v144
v_add_f32 v145, v145, v145
v_mfma_f32_32x32x16_bf16 v[80:95], a[140:143], a[52:55], v[80:95]
ds_read_b64_tr_b16 a[132:133], v22 offset:32768
ds_read_b64_tr_b16 a[134:135], v22 offset:33280
s_bitcmp1_b32 s3, 0
s_cselect_b64 vcc, -1, 0
v_cndmask_b32 v142, 1.0, v142, vcc
v_cndmask_b32 v143, 0, v143, vcc
s_waitcnt lgkmcnt(10)
v_mfma_f32_32x32x16_bf16 v[64:79], a[144:147], a[56:59], v[64:79]
ds_read_b128 a[68:71], v14 offset:0
buffer_load_dwordx4 v7, s[48:51], s12 offen offset:3072 lds
ds_read_b64_tr_b16 a[136:137], v21 offset:34816
ds_read_b64_tr_b16 a[138:139], v21 offset:35328
v_mul_f32 v148, v146, v142
v_mul_f32 v149, v146, v143
v_mfma_f32_32x32x16_bf16 v[80:95], a[148:151], a[56:59], v[80:95]
ds_read_b64_tr_b16 a[140:141], v22 offset:34816
ds_read_b64_tr_b16 a[142:143], v22 offset:35328
v_fma_f32 v148, -v147, v143, v148
v_fmac_f32 v149, v147, v142
v_mul_f32 v134, v144, v144
s_waitcnt lgkmcnt(10)
v_mfma_f32_32x32x16_bf16 v[64:79], a[152:155], a[60:63], v[64:79]
ds_read_b128 a[72:75], v15 offset:0
ds_read_b64_tr_b16 a[144:145], v21 offset:36864
s_add_u32 m0, s90, 77824
s_lshl_b32 s12, s91, 7
s_add_u32 s12, s12, s88
s_add_u32 s91, s91, 1
s_and_b32 s91, s91, 7
buffer_load_dwordx4 v4, s[48:51], s12 offen offset:0 lds
ds_read_b64_tr_b16 a[146:147], v21 offset:37376
v_mul_f32 v135, v144, v145
v_fma_f32 v134, -v145, v145, v134
v_mfma_f32_32x32x16_bf16 v[80:95], a[156:159], a[60:63], v[80:95]
ds_read_b64_tr_b16 a[148:149], v22 offset:36864
ds_read_b64_tr_b16 a[150:151], v22 offset:37376
v_add_f32 v135, v135, v135
s_bitcmp1_b32 s3, 1
s_cselect_b64 vcc, -1, 0
v_cndmask_b32 v144, 1.0, v144, vcc
buffer_load_dwordx4 v5, s[48:51], s12 offen offset:1024 lds
s_waitcnt lgkmcnt(10)
v_mfma_f32_32x32x16_bf16 v[64:79], a[128:131], a[64:67], v[64:79]
ds_read_b128 a[76:79], v16 offset:0
ds_read_b64_tr_b16 a[152:153], v21 offset:38912
ds_read_b64_tr_b16 a[154:155], v21 offset:39424
v_cndmask_b32 v145, 0, v145, vcc
v_mul_f32 v132, v148, v144
v_mfma_f32_32x32x16_bf16 v[80:95], a[132:135], a[64:67], v[80:95]
ds_read_b64_tr_b16 a[156:157], v22 offset:38912
ds_read_b64_tr_b16 a[158:159], v22 offset:39424
v_mul_f32 v133, v148, v145
v_fma_f32 v132, -v149, v145, v132
v_fmac_f32 v133, v149, v144
buffer_load_dwordx4 v6, s[48:51], s12 offen offset:2048 lds
s_waitcnt lgkmcnt(10)
v_mfma_f32_32x32x16_bf16 v[64:79], a[136:139], a[68:71], v[64:79]
s_waitcnt vmcnt(7)
s_barrier
v_mov_b32 v26, 0
global_load_dword v28, v26, s[44:45] sc1
ds_read_b128 a[80:83], v13 offset:4096
ds_read_b64_tr_b16 a[128:129], v21 offset:40960
ds_read_b64_tr_b16 a[130:131], v21 offset:41472
v_mul_f32 v142, v134, v134
v_mul_f32 v143, v134, v135
v_mfma_f32_32x32x16_bf16 v[80:95], a[140:143], a[68:71], v[80:95]
ds_read_b64_tr_b16 a[132:133], v22 offset:40960
ds_read_b64_tr_b16 a[134:135], v22 offset:41472
v_fma_f32 v142, -v135, v135, v142
v_add_f32 v143, v143, v143
buffer_load_dwordx4 v7, s[48:51], s12 offen offset:3072 lds
v_mul_f32 v144, v142, v142
s_waitcnt lgkmcnt(10)
v_mfma_f32_32x32x16_bf16 v[64:79], a[144:147], a[72:75], v[64:79]
ds_read_b128 a[84:87], v14 offset:4096
ds_read_b64_tr_b16 a[136:137], v21 offset:43008
ds_read_b64_tr_b16 a[138:139], v21 offset:43520
v_mul_f32 v145, v142, v143
v_fma_f32 v144, -v143, v143, v144
v_mfma_f32_32x32x16_bf16 v[80:95], a[148:151], a[72:75], v[80:95]
ds_read_b64_tr_b16 a[140:141], v22 offset:43008
ds_read_b64_tr_b16 a[142:143], v22 offset:43520
v_add_f32 v145, v145, v145
v_mul_f32 v146, v144, v144
s_add_u32 m0, s20, 8192
s_lshl_b32 s12, s8, 7
s_add_u32 s12, s12, s21
s_add_u32 s8, s8, 1
s_and_b32 s8, s8, 7
buffer_load_dwordx4 v8, s[56:59], s12 offen offset:0 lds
v_mul_f32 v147, v144, v145
s_waitcnt lgkmcnt(10)
v_mfma_f32_32x32x16_bf16 v[64:79], a[152:155], a[76:79], v[64:79]
ds_read_b128 a[88:91], v15 offset:4096
ds_read_b64_tr_b16 a[144:145], v21 offset:45056
ds_read_b64_tr_b16 a[146:147], v21 offset:45568
v_fma_f32 v146, -v145, v145, v146
v_add_f32 v147, v147, v147
v_mfma_f32_32x32x16_bf16 v[80:95], a[156:159], a[76:79], v[80:95]
ds_read_b64_tr_b16 a[148:149], v22 offset:45056
s_add_u32 m0, s20, 12288
s_nop 0
buffer_load_dwordx4 v8, s[60:63], s12 offen offset:0 lds
ds_read_b64_tr_b16 a[150:151], v22 offset:45568
v_cndmask_b32 v146, 1.0, v146, vcc
v_cndmask_b32 v147, 0, v147, vcc
s_bitcmp1_b32 s3, 0
s_cselect_b64 vcc, -1, 0
s_waitcnt lgkmcnt(10)
s_lshr_b32 s92, s2, 3
s_lshl_b32 s92, s92, 2
s_add_u32 s92, s92, s3
s_lshr_b32 s93, s92, 3
s_and_b32 s92, s92, 7
s_lshl_b32 s92, s92, 13
s_lshr_b32 s98, s93, 2
s_lshl_b32 s93, s93, 1
s_sub_u32 s93, s93, s98
s_lshl_b32 s93, s93, 16
s_add_u32 s92, s92, s93
v_lshl_add_u32 v243, v0, 10, s92
s_mov_b64 exec, 0xff
buffer_load_dword v241, v243, s[64:67], 0 offen offset:384
s_mov_b64 exec, -1
v_mfma_f32_32x32x16_bf16 v[64:79], a[128:131], a[80:83], v[64:79]
s_add_u32 m0, s20, 16384
s_lshl_b32 s12, s8, 7
s_add_u32 s12, s12, s21
s_add_u32 s8, s8, 1
s_and_b32 s8, s8, 7
buffer_load_dwordx4 v8, s[56:59], s12 offen offset:0 lds
ds_read_b128 a[92:95], v16 offset:4096
ds_read_b64_tr_b16 a[152:153], v21 offset:47104
ds_read_b64_tr_b16 a[154:155], v21 offset:47616
s_add_u32 m0, s20, 20480
s_nop 0
buffer_load_dwordx4 v8, s[60:63], s12 offen offset:0 lds
v_cndmask_b32 v144, 1.0, v144, vcc
v_cndmask_b32 v145, 0, v145, vcc
v_mfma_f32_32x32x16_bf16 v[80:95], a[132:135], a[80:83], v[80:95]
ds_read_b64_tr_b16 a[156:157], v22 offset:47104
ds_read_b64_tr_b16 a[158:159], v22 offset:47616
v_mul_f32 v148, v144, v146
v_mul_f32 v149, v144, v147
v_fma_f32 v148, -v145, v147, v148
s_waitcnt lgkmcnt(10)
v_mfma_f32_32x32x16_bf16 v[64:79], a[136:139], a[84:87], v[64:79]
s_waitcnt vmcnt(10)
s_barrier
ds_read_b128 a[96:99], v13 offset:8192
s_add_u32 m0, s20, 24576
s_lshl_b32 s12, s8, 7
s_add_u32 s12, s12, s21
s_add_u32 s8, s8, 1
s_and_b32 s8, s8, 7
buffer_load_dwordx4 v8, s[56:59], s12 offen offset:0 lds
ds_read_b64_tr_b16 a[128:129], v21 offset:49152
ds_read_b64_tr_b16 a[130:131], v21 offset:49664
v_fmac_f32 v149, v145, v146
v_cmp_lt_u32 vcc, 31, v0
v_mfma_f32_32x32x16_bf16 v[80:95], a[140:143], a[84:87], v[80:95]
ds_read_b64_tr_b16 a[132:133], v22 offset:49152
ds_read_b64_tr_b16 a[134:135], v22 offset:49664
v_cndmask_b32 v142, 1.0, v142, vcc
v_cndmask_b32 v143, 0, v143, vcc
s_add_u32 m0, s20, 28672
s_nop 0
buffer_load_dwordx4 v8, s[60:63], s12 offen offset:0 lds
v_mul_f32 v136, v148, v142
s_waitcnt lgkmcnt(10)
v_mfma_f32_32x32x16_bf16 v[64:79], a[144:147], a[88:91], v[64:79]
ds_read_b128 a[100:103], v14 offset:8192
ds_read_b64_tr_b16 a[136:137], v21 offset:51200
ds_read_b64_tr_b16 a[138:139], v21 offset:51712
v_mul_f32 v137, v148, v143
v_fma_f32 v136, -v149, v143, v136
v_mfma_f32_32x32x16_bf16 v[80:95], a[148:151], a[88:91], v[80:95]
ds_read_b64_tr_b16 a[140:141], v22 offset:51200
ds_read_b64_tr_b16 a[142:143], v22 offset:51712
v_fmac_f32 v137, v149, v142
s_add_u32 m0, s20, 32768
s_lshl_b32 s12, s8, 7
s_add_u32 s12, s12, s21
s_add_u32 s8, s8, 1
s_and_b32 s8, s8, 7
buffer_load_dwordx4 v8, s[56:59], s12 offen offset:0 lds
s_lshl_b32 s94, s3, 9
s_add_u32 s94, s94, 131072
v_lshrrev_b32 v1, 5, v0
v_and_b32 v2, 31, v0
s_waitcnt lgkmcnt(10)
v_mfma_f32_32x32x16_bf16 v[64:79], a[152:155], a[92:95], v[64:79]
ds_read_b128 a[104:107], v15 offset:8192
ds_read_b64_tr_b16 a[144:145], v21 offset:53248
ds_read_b64_tr_b16 a[146:147], v21 offset:53760
v_lshlrev_b32 v151, 4, v2
s_lshl_b32 s95, s3, 1
v_add_u32 v3, s95, v1
s_add_u32 m0, s20, 36864
s_nop 0
buffer_load_dwordx4 v8, s[60:63], s12 offen offset:0 lds
v_mfma_f32_32x32x16_bf16 v[80:95], a[156:159], a[92:95], v[80:95]
ds_read_b64_tr_b16 a[148:149], v22 offset:53248
ds_read_b64_tr_b16 a[150:151], v22 offset:53760
v_lshl_add_u32 v158, v3, 10, v151
v_lshlrev_b32 v159, 1, v3
v_sub_u32 v159, s4, v159
s_waitcnt lgkmcnt(10)
v_mfma_f32_32x32x16_bf16 v[64:79], a[128:131], a[96:99], v[64:79]
ds_read_b128 a[108:111], v16 offset:8192
ds_read_b64_tr_b16 a[152:153], v21 offset:55296
ds_read_b64_tr_b16 a[154:155], v21 offset:55808
v_med3_i32 v159, v159, 0, 2
v_lshlrev_b32 v1, 8, v1
v_mfma_f32_32x32x16_bf16 v[80:95], a[132:135], a[96:99], v[80:95]
ds_read_b64_tr_b16 a[156:157], v22 offset:55296
ds_read_b64_tr_b16 a[158:159], v22 offset:55808
v_lshl_add_u32 v1, v2, 3, v1
v_add_u32 v150, s94, v1
v_bfe_u32 v2, v0, 2, 1
s_waitcnt lgkmcnt(10)
v_mfma_f32_32x32x16_bf16 v[64:79], a[136:139], a[100:103], v[64:79]
s_waitcnt vmcnt(9)
s_barrier
ds_read_b128 a[112:115], v13 offset:12288
s_add_u32 m0, s20, 40960
s_lshl_b32 s12, s8, 7
s_add_u32 s12, s12, s21
s_add_u32 s8, s8, 1
s_and_b32 s8, s8, 7
buffer_load_dwordx4 v8, s[56:59], s12 offen offset:0 lds
s_add_u32 m0, s20, 45056
s_nop 0
buffer_load_dwordx4 v8, s[60:63], s12 offen offset:0 lds
ds_read_b64_tr_b16 a[128:129], v21 offset:57344
ds_read_b64_tr_b16 a[130:131], v21 offset:57856
v_lshlrev_b32 v2, 4, v2
v_and_b32 v3, 3, v0
v_mfma_f32_32x32x16_bf16 v[80:95], a[140:143], a[100:103], v[80:95]
ds_read_b64_tr_b16 a[132:133], v22 offset:57344
ds_read_b64_tr_b16 a[134:135], v22 offset:57856
v_add_u32 v1, v2, v3
v_bfe_u32 v2, v0, 3, 2
v_lshl_add_u32 v1, v2, 2, v1
s_waitcnt lgkmcnt(10)
v_mfma_f32_32x32x16_bf16 v[64:79], a[144:147], a[104:107], v[64:79]
ds_read_b128 a[116:119], v14 offset:12288
ds_read_b64_tr_b16 a[136:137], v21 offset:59392
ds_read_b64_tr_b16 a[138:139], v21 offset:59904
v_lshlrev_b32 v157, 2, v1
v_mfma_f32_32x32x16_bf16 v[80:95], a[148:151], a[104:107], v[80:95]
ds_read_b64_tr_b16 a[140:141], v22 offset:59392
ds_read_b64_tr_b16 a[142:143], v22 offset:59904
s_waitcnt lgkmcnt(10)
v_mfma_f32_32x32x16_bf16 v[64:79], a[152:155], a[108:111], v[64:79]
ds_read_b128 a[120:123], v15 offset:12288
ds_read_b64_tr_b16 a[144:145], v21 offset:61440
ds_read_b64_tr_b16 a[146:147], v21 offset:61952
v_mfma_f32_32x32x16_bf16 v[80:95], a[156:159], a[108:111], v[80:95]
ds_read_b64_tr_b16 a[148:149], v22 offset:61440
ds_read_b64_tr_b16 a[150:151], v22 offset:61952
s_waitcnt lgkmcnt(10)
v_mfma_f32_32x32x16_bf16 v[64:79], a[128:131], a[112:115], v[64:79]
ds_read_b128 a[124:127], v16 offset:12288
ds_read_b64_tr_b16 a[152:153], v21 offset:63488
ds_read_b64_tr_b16 a[154:155], v21 offset:64000
v_mfma_f32_32x32x16_bf16 v[80:95], a[132:135], a[112:115], v[80:95]
ds_read_b64_tr_b16 a[156:157], v22 offset:63488
ds_read_b64_tr_b16 a[158:159], v22 offset:64000
s_waitcnt lgkmcnt(10)
v_mfma_f32_32x32x16_bf16 v[64:79], a[136:139], a[116:119], v[64:79]
s_waitcnt vmcnt(9)
s_barrier
ds_read_b128 a[160:163], v17 offset:0
v_mfma_f32_32x32x16_bf16 v[80:95], a[140:143], a[116:119], v[80:95]
ds_read_b128 a[164:167], v17 offset:4096
s_waitcnt lgkmcnt(7)
v_mfma_f32_32x32x16_bf16 v[64:79], a[144:147], a[120:123], v[64:79]
ds_read_b128 a[168:171], v18 offset:0
v_mfma_f32_32x32x16_bf16 v[80:95], a[148:151], a[120:123], v[80:95]
ds_read_b128 a[172:175], v18 offset:4096
s_waitcnt lgkmcnt(4)
v_mfma_f32_32x32x16_bf16 v[64:79], a[152:155], a[124:127], v[64:79]
v_lshrrev_b32 v7, 3, v0
v_lshlrev_b32 v7, 10, v7
v_bfe_u32 v6, v0, 4, 1
v_lshlrev_b32 v6, 2, v6
v_and_b32 v5, 7, v0
v_xor_b32 v6, v6, v5
v_lshl_add_u32 v4, v6, 4, v7
v_add_u32 v5, 7168, v4
v_add_u32 v6, 14336, v4
v_add_u32 v7, 21504, v4
s_add_u32 m0, s90, 65536
s_lshl_b32 s12, s34, 16
s_lshl_b32 s13, s7, 7
s_add_u32 s12, s12, s13
buffer_load_dwordx4 v4, s[64:67], s12 offen offset:0 lds
buffer_load_dwordx4 v5, s[64:67], s12 offen offset:1024 lds
buffer_load_dwordx4 v6, s[64:67], s12 offen offset:2048 lds
ds_read_b128 a[176:179], v19 offset:0
v_mfma_f32_32x32x16_bf16 v[80:95], a[156:159], a[124:127], v[80:95]
ds_read_b128 a[180:183], v19 offset:4096
s_waitcnt lgkmcnt(4)
v_mfma_f32_32x32x16_bf16 v[32:47], a[0:3], a[160:163], 0
ds_read_b128 a[184:187], v20 offset:0
v_cvt_pk_bf16_f32 v64, v64, v65
v_cvt_pk_bf16_f32 v65, v66, v67
v_cvt_pk_bf16_f32 v66, v68, v69
buffer_load_dwordx4 v7, s[64:67], s12 offen offset:3072 lds
v_mfma_f32_32x32x16_bf16 v[48:63], a[0:3], a[164:167], 0
ds_read_b128 a[188:191], v20 offset:4096
v_cvt_pk_bf16_f32 v67, v70, v71
v_pk_max_i16 v64, v64, 0
v_pk_max_i16 v65, v65, 0
s_waitcnt lgkmcnt(4)
v_mfma_f32_32x32x16_bf16 v[32:47], a[4:7], a[168:171], v[32:47]
ds_read_b128 a[160:163], v17 offset:8192
v_pk_max_i16 v66, v66, 0
v_pk_max_i16 v67, v67, 0
v_cvt_pk_bf16_f32 v72, v72, v73
v_mfma_f32_32x32x16_bf16 v[48:63], a[4:7], a[172:175], v[48:63]
s_add_u32 m0, s90, 69632
s_add_u32 s12, s12, 32768
buffer_load_dwordx4 v4, s[64:67], s12 offen offset:0 lds
ds_read_b128 a[164:167], v17 offset:12288
v_cvt_pk_bf16_f32 v73, v74, v75
v_cvt_pk_bf16_f32 v74, v76, v77
v_cvt_pk_bf16_f32 v75, v78, v79
s_waitcnt lgkmcnt(4)
v_mfma_f32_32x32x16_bf16 v[32:47], a[8:11], a[176:179], v[32:47]
ds_read_b128 a[168:171], v18 offset:8192
v_pk_max_i16 v72, v72, 0
v_pk_max_i16 v73, v73, 0
v_pk_max_i16 v74, v74, 0
v_mfma_f32_32x32x16_bf16 v[48:63], a[8:11], a[180:183], v[48:63]
buffer_load_dwordx4 v5, s[64:67], s12 offen offset:1024 lds
ds_read_b128 a[172:175], v18 offset:12288
v_pk_max_i16 v75, v75, 0
v_cvt_pk_bf16_f32 v80, v80, v81
v_cvt_pk_bf16_f32 v81, v82, v83
s_waitcnt lgkmcnt(4)
v_mfma_f32_32x32x16_bf16 v[32:47], a[12:15], a[184:187], v[32:47]
ds_read_b128 a[176:179], v19 offset:8192
v_cvt_pk_bf16_f32 v82, v84, v85
v_cvt_pk_bf16_f32 v83, v86, v87
v_pk_max_i16 v80, v80, 0
v_mfma_f32_32x32x16_bf16 v[48:63], a[12:15], a[188:191], v[48:63]
buffer_load_dwordx4 v6, s[64:67], s12 offen offset:2048 lds
ds_read_b128 a[180:183], v19 offset:12288
v_pk_max_i16 v81, v81, 0
v_pk_max_i16 v82, v82, 0
v_pk_max_i16 v83, v83, 0
s_waitcnt lgkmcnt(4)
v_mfma_f32_32x32x16_bf16 v[32:47], a[16:19], a[160:163], v[32:47]
ds_read_b128 a[184:187], v20 offset:8192
v_cvt_pk_bf16_f32 v88, v88, v89
v_cvt_pk_bf16_f32 v89, v90, v91
v_cvt_pk_bf16_f32 v90, v92, v93
v_mfma_f32_32x32x16_bf16 v[48:63], a[16:19], a[164:167], v[48:63]
ds_read_b128 a[188:191], v20 offset:12288
buffer_load_dwordx4 v7, s[64:67], s12 offen offset:3072 lds
v_cvt_pk_bf16_f32 v91, v94, v95
v_pk_max_i16 v88, v88, 0
v_pk_max_i16 v89, v89, 0
s_waitcnt lgkmcnt(4)
v_mfma_f32_32x32x16_bf16 v[32:47], a[20:23], a[168:171], v[32:47]
s_waitcnt vmcnt(12)
s_barrier
ds_read_b128 a[160:163], v17 offset:16384
v_pk_max_i16 v90, v90, 0
v_pk_max_i16 v91, v91, 0
v_readfirstlane_b32 s10, v28
s_nop 0
s_cmp_lg_u32 s10, 0
s_cbranch_scc1 L_nonce_ok
s_mov_b32 s98, 20000
v_mov_b32 v26, 0
L_nonce_loop:
s_sleep 2
global_load_dword v28, v26, s[44:45] sc1
s_waitcnt vmcnt(0)
v_readfirstlane_b32 s10, v28
s_nop 0
s_cmp_lg_u32 s10, 0
s_cbranch_scc1 L_nonce_ok
s_sub_u32 s98, s98, 1
s_cmp_lg_u32 s98, 0
s_cbranch_scc1 L_nonce_loop
L_nonce_ok:
s_not_b32 s11, s10
v_mov_b32 v154, s10
v_mov_b32 v155, s11
s_add_u32 m0, s20, 49152
s_lshl_b32 s12, s8, 7
s_add_u32 s12, s12, s21
s_add_u32 s8, s8, 1
s_and_b32 s8, s8, 7
buffer_load_dwordx4 v8, s[56:59], s12 offen offset:0 lds
s_add_u32 m0, s20, 53248
s_nop 0
buffer_load_dwordx4 v8, s[60:63], s12 offen offset:0 lds
s_lshr_b32 s31, s88, 16
s_lshl_b32 s31, s31, 2
s_lshr_b32 s92, s5, 2
s_add_u32 s31, s31, s92
s_lshl_b32 s31, s31, 5
s_and_b32 s92, s3, 1
s_lshl_b32 s92, s92, 2
s_add_u32 s31, s31, s92
s_and_b32 s92, s5, 3
s_add_u32 s31, s31, s92
s_lshl_b32 s31, s31, 2
s_lshl_b32 s45, s6, 2
s_add_u32 s45, s45, s3
s_lshl_b32 s45, s45, 7
s_add_u32 m0, s20, 57344
s_lshl_b32 s12, s8, 7
s_add_u32 s12, s12, s21
s_add_u32 s8, s8, 1
s_and_b32 s8, s8, 7
buffer_load_dwordx4 v8, s[56:59], s12 offen offset:0 lds
v_mfma_f32_32x32x16_bf16 v[48:63], a[20:23], a[172:175], v[48:63]
ds_read_b128 a[164:167], v17 offset:20480
s_add_u32 m0, s20, 61440
s_nop 0
buffer_load_dwordx4 v8, s[60:63], s12 offen offset:0 lds
buffer_store_dwordx4 v[64:67], v31, s[76:79], s97 offen offset:0 sc1
buffer_store_dwordx4 v[72:75], v31, s[76:79], s97 offen offset:128 sc1
buffer_store_dwordx4 v[80:83], v31, s[76:79], s97 offen offset:256 sc1
buffer_store_dwordx4 v[88:91], v31, s[76:79], s97 offen offset:384 sc1
s_waitcnt lgkmcnt(4)
v_mfma_f32_32x32x16_bf16 v[32:47], a[24:27], a[176:179], v[32:47]
ds_read_b128 a[168:171], v18 offset:16384
v_mfma_f32_32x32x16_bf16 v[48:63], a[24:27], a[180:183], v[48:63]
ds_read_b128 a[172:175], v18 offset:20480
s_waitcnt lgkmcnt(4)
v_mfma_f32_32x32x16_bf16 v[32:47], a[28:31], a[184:187], v[32:47]
ds_read_b128 a[176:179], v19 offset:16384
v_mfma_f32_32x32x16_bf16 v[48:63], a[28:31], a[188:191], v[48:63]
ds_read_b128 a[180:183], v19 offset:20480
s_waitcnt lgkmcnt(4)
v_mfma_f32_32x32x16_bf16 v[32:47], a[32:35], a[160:163], v[32:47]
ds_read_b128 a[184:187], v20 offset:16384
v_mfma_f32_32x32x16_bf16 v[48:63], a[32:35], a[164:167], v[48:63]
ds_read_b128 a[188:191], v20 offset:20480
s_waitcnt lgkmcnt(4)
v_mfma_f32_32x32x16_bf16 v[32:47], a[36:39], a[168:171], v[32:47]
ds_read_b128 a[160:163], v17 offset:24576
v_mfma_f32_32x32x16_bf16 v[48:63], a[36:39], a[172:175], v[48:63]
ds_read_b128 a[164:167], v17 offset:28672
s_waitcnt lgkmcnt(4)
v_mfma_f32_32x32x16_bf16 v[32:47], a[40:43], a[176:179], v[32:47]
ds_read_b128 a[168:171], v18 offset:24576
v_mfma_f32_32x32x16_bf16 v[48:63], a[40:43], a[180:183], v[48:63]
ds_read_b128 a[172:175], v18 offset:28672
s_waitcnt lgkmcnt(4)
v_mfma_f32_32x32x16_bf16 v[32:47], a[44:47], a[184:187], v[32:47]
ds_read_b128 a[176:179], v19 offset:24576
v_mfma_f32_32x32x16_bf16 v[48:63], a[44:47], a[188:191], v[48:63]
s_add_u32 m0, s90, 73728
s_lshl_b32 s12, s35, 16
s_lshl_b32 s13, s7, 7
s_add_u32 s12, s12, s13
buffer_load_dwordx4 v4, s[64:67], s12 offen offset:0 lds
ds_read_b128 a[180:183], v19 offset:28672
s_waitcnt lgkmcnt(4)
v_mfma_f32_32x32x16_bf16 v[32:47], a[48:51], a[160:163], v[32:47]
ds_read_b128 a[184:187], v20 offset:24576
v_mfma_f32_32x32x16_bf16 v[48:63], a[48:51], a[164:167], v[48:63]
buffer_load_dwordx4 v5, s[64:67], s12 offen offset:1024 lds
ds_read_b128 a[188:191], v20 offset:28672
s_waitcnt lgkmcnt(4)
v_mfma_f32_32x32x16_bf16 v[32:47], a[52:55], a[168:171], v[32:47]
s_waitcnt vmcnt(18)
s_barrier
ds_read_b128 a[160:163], v17 offset:32768
v_mfma_f32_32x32x16_bf16 v[48:63], a[52:55], a[172:175], v[48:63]
ds_read_b128 a[164:167], v17 offset:36864
s_waitcnt lgkmcnt(4)
v_mfma_f32_32x32x16_bf16 v[32:47], a[56:59], a[176:179], v[32:47]
buffer_load_dwordx4 v6, s[64:67], s12 offen offset:2048 lds
ds_read_b128 a[168:171], v18 offset:32768
v_mfma_f32_32x32x16_bf16 v[48:63], a[56:59], a[180:183], v[48:63]
ds_read_b128 a[172:175], v18 offset:36864
s_waitcnt lgkmcnt(4)
v_mfma_f32_32x32x16_bf16 v[32:47], a[60:63], a[184:187], v[32:47]
buffer_load_dwordx4 v7, s[64:67], s12 offen offset:3072 lds
ds_read_b128 a[176:179], v19 offset:32768
v_mfma_f32_32x32x16_bf16 v[48:63], a[60:63], a[188:191], v[48:63]
ds_read_b128 a[180:183], v19 offset:36864
s_waitcnt lgkmcnt(4)
v_mfma_f32_32x32x16_bf16 v[32:47], a[64:67], a[160:163], v[32:47]
s_add_u32 m0, s90, 77824
s_add_u32 s12, s12, 32768
buffer_load_dwordx4 v4, s[64:67], s12 offen offset:0 lds
ds_read_b128 a[184:187], v20 offset:32768
v_mfma_f32_32x32x16_bf16 v[48:63], a[64:67], a[164:167], v[48:63]
ds_read_b128 a[188:191], v20 offset:36864
s_waitcnt lgkmcnt(4)
v_mfma_f32_32x32x16_bf16 v[32:47], a[68:71], a[168:171], v[32:47]
buffer_load_dwordx4 v5, s[64:67], s12 offen offset:1024 lds
ds_read_b128 a[160:163], v17 offset:40960
v_mfma_f32_32x32x16_bf16 v[48:63], a[68:71], a[172:175], v[48:63]
ds_read_b128 a[164:167], v17 offset:45056
s_waitcnt lgkmcnt(4)
v_mfma_f32_32x32x16_bf16 v[32:47], a[72:75], a[176:179], v[32:47]
buffer_load_dwordx4 v6, s[64:67], s12 offen offset:2048 lds
ds_read_b128 a[168:171], v18 offset:40960
v_mfma_f32_32x32x16_bf16 v[48:63], a[72:75], a[180:183], v[48:63]
ds_read_b128 a[172:175], v18 offset:45056
s_waitcnt lgkmcnt(4)
v_mfma_f32_32x32x16_bf16 v[32:47], a[76:79], a[184:187], v[32:47]
ds_read_b128 a[176:179], v19 offset:40960
buffer_load_dwordx4 v7, s[64:67], s12 offen offset:3072 lds
v_mfma_f32_32x32x16_bf16 v[48:63], a[76:79], a[188:191], v[48:63]
ds_read_b128 a[180:183], v19 offset:45056
s_waitcnt lgkmcnt(4)
v_mfma_f32_32x32x16_bf16 v[32:47], a[80:83], a[160:163], v[32:47]
ds_read_b128 a[184:187], v20 offset:40960
v_mfma_f32_32x32x16_bf16 v[48:63], a[80:83], a[164:167], v[48:63]
s_lshl_b32 s20, s20, 1
s_lshl_b32 s12, s3, 5
s_cmp_eq_u32 s30, 128
s_cselect_b32 s21, s12, s89
s_add_u32 m0, s20, 0
s_mul_i32 s12, s8, s30
s_add_u32 s12, s12, s21
s_add_u32 s8, s8, 1
s_and_b32 s8, s8, 7
buffer_load_dwordx4 v11, s[24:27], s12 offen offset:0 lds
ds_read_b128 a[188:191], v20 offset:45056
s_waitcnt lgkmcnt(4)
v_mfma_f32_32x32x16_bf16 v[32:47], a[84:87], a[168:171], v[32:47]
buffer_load_dwordx4 v12, s[24:27], s12 offen offset:1024 lds
s_waitcnt vmcnt(14)
s_barrier
s_add_u32 m0, s20, 8192
s_mul_i32 s12, s8, s30
s_add_u32 s12, s12, s21
s_add_u32 s8, s8, 1
s_and_b32 s8, s8, 7
buffer_load_dwordx4 v11, s[24:27], s12 offen offset:0 lds
buffer_load_dwordx4 v12, s[24:27], s12 offen offset:1024 lds
ds_read_b128 a[160:163], v17 offset:49152
v_mfma_f32_32x32x16_bf16 v[48:63], a[84:87], a[172:175], v[48:63]
ds_read_b128 a[164:167], v17 offset:53248
s_waitcnt lgkmcnt(4)
v_mfma_f32_32x32x16_bf16 v[32:47], a[88:91], a[176:179], v[32:47]
ds_read_b128 a[168:171], v18 offset:49152
ds_read_b64_tr_b16 a[192:193], v23 offset:0
ds_read_b64_tr_b16 a[194:195], v23 offset:1024
v_mfma_f32_32x32x16_bf16 v[48:63], a[88:91], a[180:183], v[48:63]
ds_read_b128 a[172:175], v18 offset:53248
ds_read_b64_tr_b16 a[196:197], v24 offset:0
ds_read_b64_tr_b16 a[198:199], v24 offset:1024
s_waitcnt lgkmcnt(8)
v_mfma_f32_32x32x16_bf16 v[32:47], a[92:95], a[184:187], v[32:47]
ds_read_b128 a[176:179], v19 offset:49152
ds_read_b64_tr_b16 a[200:201], v23 offset:2048
ds_read_b64_tr_b16 a[202:203], v23 offset:3072
v_mfma_f32_32x32x16_bf16 v[48:63], a[92:95], a[188:191], v[48:63]
ds_read_b128 a[180:183], v19 offset:53248
ds_read_b64_tr_b16 a[204:205], v24 offset:2048
ds_read_b64_tr_b16 a[206:207], v24 offset:3072
s_waitcnt lgkmcnt(12)
v_mfma_f32_32x32x16_bf16 v[32:47], a[96:99], a[160:163], v[32:47]
s_add_u32 m0, s20, 16384
s_mul_i32 s12, s8, s30
s_add_u32 s12, s12, s21
s_add_u32 s8, s8, 1
s_and_b32 s8, s8, 7
buffer_load_dwordx4 v11, s[24:27], s12 offen offset:0 lds
ds_read_b128 a[184:187], v20 offset:49152
ds_read_b64_tr_b16 a[208:209], v23 offset:4096
ds_read_b64_tr_b16 a[210:211], v23 offset:5120
v_mfma_f32_32x32x16_bf16 v[48:63], a[96:99], a[164:167], v[48:63]
ds_read_b128 a[188:191], v20 offset:53248
ds_read_b64_tr_b16 a[212:213], v24 offset:4096
ds_read_b64_tr_b16 a[214:215], v24 offset:5120
s_waitcnt lgkmcnt(14)
v_mfma_f32_32x32x16_bf16 v[32:47], a[100:103], a[168:171], v[32:47]
buffer_load_dwordx4 v12, s[24:27], s12 offen offset:1024 lds
ds_read_b128 a[160:163], v17 offset:57344
ds_read_b64_tr_b16 a[216:217], v23 offset:6144
ds_read_b64_tr_b16 a[218:219], v23 offset:7168
v_mfma_f32_32x32x16_bf16 v[48:63], a[100:103], a[172:175], v[48:63]
ds_read_b128 a[164:167], v17 offset:61440
ds_read_b64_tr_b16 a[220:221], v24 offset:6144
ds_read_b64_tr_b16 a[222:223], v24 offset:7168
s_waitcnt lgkmcnt(14)
v_mfma_f32_32x32x16_bf16 v[32:47], a[104:107], a[176:179], v[32:47]
s_add_u32 m0, s20, 24576
s_mul_i32 s12, s8, s30
s_add_u32 s12, s12, s21
s_add_u32 s8, s8, 1
s_and_b32 s8, s8, 7
buffer_load_dwordx4 v11, s[24:27], s12 offen offset:0 lds
ds_read_b128 a[168:171], v18 offset:57344
v_mfma_f32_32x32x16_bf16 v[48:63], a[104:107], a[180:183], v[48:63]
ds_read_b128 a[172:175], v18 offset:61440
s_waitcnt lgkmcnt(2)
v_mfma_f32_32x32x16_bf16 v[32:47], a[108:111], a[184:187], v[32:47]
buffer_load_dwordx4 v12, s[24:27], s12 offen offset:1024 lds
ds_read_b128 a[176:179], v19 offset:57344
v_mfma_f32_32x32x16_bf16 v[48:63], a[108:111], a[188:191], v[48:63]
ds_read_b128 a[180:183], v19 offset:61440
s_lshr_b32 s92, s2, 3
s_lshl_b32 s92, s92, 2
s_add_u32 s92, s92, s3
s_lshr_b32 s93, s92, 3
s_and_b32 s92, s92, 7
s_lshl_b32 s92, s92, 13
s_mul_i32 s98, s93, 43
s_lshr_b32 s98, s98, 7
s_lshl_b32 s93, s93, 1
s_add_u32 s93, s93, s98
s_add_u32 s93, s93, 1
s_lshl_b32 s93, s93, 16
s_add_u32 s92, s92, s93
v_lshl_add_u32 v243, v0, 10, s92
s_mov_b64 exec, 0xff
buffer_load_dword v241, v243, s[64:67], 0 offen offset:384
s_mov_b64 exec, -1
v_mfma_f32_32x32x16_bf16 v[32:47], a[112:115], a[160:163], v[32:47]
s_add_u32 m0, s90, 65536
s_lshl_b32 s12, s36, 16
s_lshl_b32 s13, s7, 7
s_add_u32 s12, s12, s13
buffer_load_dwordx4 v4, s[64:67], s12 offen offset:0 lds
ds_read_b128 a[184:187], v20 offset:57344
v_mfma_f32_32x32x16_bf16 v[48:63], a[112:115], a[164:167], v[48:63]
buffer_load_dwordx4 v5, s[64:67], s12 offen offset:1024 lds
ds_read_b128 a[188:191], v20 offset:61440
s_waitcnt lgkmcnt(4)
v_mfma_f32_32x32x16_bf16 v[32:47], a[116:119], a[168:171], v[32:47]
s_waitcnt vmcnt(7)
s_barrier
ds_read_b64_tr_b16 a[128:129], v21 offset:0
ds_read_b64_tr_b16 a[130:131], v21 offset:512
v_mfma_f32_32x32x16_bf16 v[48:63], a[116:119], a[172:175], v[48:63]
ds_read_b64_tr_b16 a[132:133], v22 offset:0
buffer_load_dwordx4 v6, s[64:67], s12 offen offset:2048 lds
ds_read_b64_tr_b16 a[134:135], v22 offset:512
s_waitcnt lgkmcnt(6)
v_mfma_f32_32x32x16_bf16 v[32:47], a[120:123], a[176:179], v[32:47]
ds_read_b64_tr_b16 a[136:137], v21 offset:2048
ds_read_b64_tr_b16 a[138:139], v21 offset:2560
ds_read_b64_tr_b16 a[224:225], v23 offset:8192
ds_read_b64_tr_b16 a[226:227], v23 offset:9216
v_mfma_f32_32x32x16_bf16 v[48:63], a[120:123], a[180:183], v[48:63]
ds_read_b64_tr_b16 a[140:141], v22 offset:2048
ds_read_b64_tr_b16 a[142:143], v22 offset:2560
buffer_load_dwordx4 v7, s[64:67], s12 offen offset:3072 lds
ds_read_b64_tr_b16 a[228:229], v24 offset:8192
ds_read_b64_tr_b16 a[230:231], v24 offset:9216
s_waitcnt lgkmcnt(12)
v_mfma_f32_32x32x16_bf16 v[32:47], a[124:127], a[184:187], v[32:47]
ds_read_b64_tr_b16 a[144:145], v21 offset:4096
ds_read_b64_tr_b16 a[146:147], v21 offset:4608
ds_read_b64_tr_b16 a[232:233], v23 offset:10240
ds_read_b64_tr_b16 a[234:235], v23 offset:11264
v_mfma_f32_32x32x16_bf16 v[48:63], a[124:127], a[188:191], v[48:63]
ds_read_b64_tr_b16 a[148:149], v22 offset:4096
ds_read_b64_tr_b16 a[150:151], v22 offset:4608
ds_read_b64_tr_b16 a[236:237], v24 offset:10240
ds_read_b64_tr_b16 a[238:239], v24 offset:11264
s_add_u32 m0, s90, 69632
s_add_u32 s12, s12, 32768
buffer_load_dwordx4 v4, s[64:67], s12 offen offset:0 lds
s_waitcnt lgkmcnt(15)
v_mfma_f32_32x32x16_bf16 v[96:111], a[128:131], a[0:3], 0
ds_read_b64_tr_b16 a[152:153], v21 offset:6144
ds_read_b64_tr_b16 a[154:155], v21 offset:6656
ds_read_b64_tr_b16 a[240:241], v23 offset:12288
ds_read_b64_tr_b16 a[242:243], v23 offset:13312
v_fma_f32 v144, v128, v32, v33
v_fma_f32 v145, v128, v48, v49
v_fma_f32 v144, -v129, v48, v144
v_fmac_f32 v145, v129, v32
v_mfma_f32_32x32x16_bf16 v[112:127], a[132:135], a[0:3], 0
ds_read_b64_tr_b16 a[156:157], v22 offset:6144
buffer_load_dwordx4 v5, s[64:67], s12 offen offset:1024 lds
ds_read_b64_tr_b16 a[158:159], v22 offset:6656
ds_read_b64_tr_b16 a[244:245], v24 offset:12288
ds_read_b64_tr_b16 a[246:247], v24 offset:13312
v_fma_f32 v142, v128, v144, v34
v_fma_f32 v143, v128, v145, v50
v_fma_f32 v142, -v129, v145, v142
v_fmac_f32 v143, v129, v144
s_waitcnt lgkmcnt(15)
v_mfma_f32_32x32x16_bf16 v[96:111], a[136:139], a[4:7], v[96:111]
ds_read_b64_tr_b16 a[128:129], v21 offset:8192
ds_read_b64_tr_b16 a[130:131], v21 offset:8704
ds_read_b64_tr_b16 a[248:249], v23 offset:14336
ds_read_b64_tr_b16 a[250:251], v23 offset:15360
v_fma_f32 v144, v128, v142, v35
v_fma_f32 v145, v128, v143, v51
buffer_load_dwordx4 v6, s[64:67], s12 offen offset:2048 lds
v_fma_f32 v144, -v129, v143, v144
v_fmac_f32 v145, v129, v142
v_mfma_f32_32x32x16_bf16 v[112:127], a[140:143], a[4:7], v[112:127]
ds_read_b64_tr_b16 a[132:133], v22 offset:8192
ds_read_b64_tr_b16 a[134:135], v22 offset:8704
ds_read_b64_tr_b16 a[252:253], v24 offset:14336
ds_read_b64_tr_b16 a[254:255], v24 offset:15360
v_fma_f32 v142, v128, v144, v36
v_fma_f32 v143, v128, v145, v52
v_fma_f32 v142, -v129, v145, v142
v_fmac_f32 v143, v129, v144
s_waitcnt lgkmcnt(15)
v_mfma_f32_32x32x16_bf16 v[96:111], a[144:147], a[8:11], v[96:111]
ds_read_b64_tr_b16 a[136:137], v21 offset:10240
buffer_load_dwordx4 v7, s[64:67], s12 offen offset:3072 lds
ds_read_b64_tr_b16 a[138:139], v21 offset:10752
v_fma_f32 v144, v128, v142, v37
v_fma_f32 v145, v128, v143, v53
v_fma_f32 v144, -v129, v143, v144
v_fmac_f32 v145, v129, v142
v_mfma_f32_32x32x16_bf16 v[112:127], a[148:151], a[8:11], v[112:127]
ds_read_b64_tr_b16 a[140:141], v22 offset:10240
ds_read_b64_tr_b16 a[142:143], v22 offset:10752
v_fma_f32 v142, v128, v144, v38
v_fma_f32 v143, v128, v145, v54
v_fma_f32 v142, -v129, v145, v142
v_fmac_f32 v143, v129, v144
s_waitcnt lgkmcnt(4)
v_mfma_f32_32x32x16_bf16 v[96:111], a[152:155], a[12:15], v[96:111]
s_add_u32 m0, s20, 32768
s_mul_i32 s12, s8, s30
s_add_u32 s12, s12, s21
s_add_u32 s8, s8, 1
s_and_b32 s8, s8, 7
buffer_load_dwordx4 v11, s[24:27], s12 offen offset:0 lds
ds_read_b64_tr_b16 a[144:145], v21 offset:12288
ds_read_b64_tr_b16 a[146:147], v21 offset:12800
v_fma_f32 v144, v128, v142, v39
v_fma_f32 v145, v128, v143, v55
v_fma_f32 v144, -v129, v143, v144
v_fmac_f32 v145, v129, v142
v_mfma_f32_32x32x16_bf16 v[112:127], a[156:159], a[12:15], v[112:127]
ds_read_b64_tr_b16 a[148:149], v22 offset:12288
ds_read_b64_tr_b16 a[150:151], v22 offset:12800
buffer_load_dwordx4 v12, s[24:27], s12 offen offset:1024 lds
v_fma_f32 v142, v128, v144, v40
v_fma_f32 v143, v128, v145, v56
v_fma_f32 v142, -v129, v145, v142
v_fmac_f32 v143, v129, v144
v_mfma_f32_32x32x16_bf16 v[96:111], a[128:131], a[16:19], v[96:111]
ds_read_b64_tr_b16 a[152:153], v21 offset:14336
ds_read_b64_tr_b16 a[154:155], v21 offset:14848
v_fma_f32 v144, v128, v142, v41
v_fma_f32 v145, v128, v143, v57
v_fma_f32 v144, -v129, v143, v144
v_fmac_f32 v145, v129, v142
v_mfma_f32_32x32x16_bf16 v[112:127], a[132:135], a[16:19], v[112:127]
ds_read_b64_tr_b16 a[156:157], v22 offset:14336
s_add_u32 m0, s20, 40960
s_mul_i32 s12, s8, s30
s_add_u32 s12, s12, s21
s_add_u32 s8, s8, 1
s_and_b32 s8, s8, 7
buffer_load_dwordx4 v11, s[24:27], s12 offen offset:0 lds
ds_read_b64_tr_b16 a[158:159], v22 offset:14848
v_fma_f32 v142, v128, v144, v42
v_fma_f32 v143, v128, v145, v58
v_fma_f32 v142, -v129, v145, v142
v_fmac_f32 v143, v129, v144
s_waitcnt lgkmcnt(8)
v_mfma_f32_32x32x16_bf16 v[96:111], a[136:139], a[20:23], v[96:111]
s_waitcnt vmcnt(12)
s_barrier
buffer_load_dwordx4 v12, s[24:27], s12 offen offset:1024 lds
ds_read_b64_tr_b16 a[128:129], v21 offset:16384
ds_read_b64_tr_b16 a[130:131], v21 offset:16896
v_fma_f32 v144, v128, v142, v43
v_fma_f32 v145, v128, v143, v59
v_fma_f32 v144, -v129, v143, v144
v_fmac_f32 v145, v129, v142
v_mfma_f32_32x32x16_bf16 v[112:127], a[140:143], a[20:23], v[112:127]
ds_read_b64_tr_b16 a[132:133], v22 offset:16384
ds_read_b64_tr_b16 a[134:135], v22 offset:16896
v_fma_f32 v142, v128, v144, v44
v_fma_f32 v143, v128, v145, v60
v_fma_f32 v142, -v129, v145, v142
v_fmac_f32 v143, v129, v144
s_waitcnt lgkmcnt(8)
v_mfma_f32_32x32x16_bf16 v[96:111], a[144:147], a[24:27], v[96:111]
ds_read_b64_tr_b16 a[136:137], v21 offset:18432
s_add_u32 m0, s20, 49152
s_mul_i32 s12, s8, s30
s_add_u32 s12, s12, s21
s_add_u32 s8, s8, 1
s_and_b32 s8, s8, 7
buffer_load_dwordx4 v11, s[24:27], s12 offen offset:0 lds
ds_read_b64_tr_b16 a[138:139], v21 offset:18944
v_fma_f32 v144, v128, v142, v45
v_fma_f32 v145, v128, v143, v61
v_fma_f32 v144, -v129, v143, v144
v_fmac_f32 v145, v129, v142
v_mfma_f32_32x32x16_bf16 v[112:127], a[148:151], a[24:27], v[112:127]
ds_read_b64_tr_b16 a[140:141], v22 offset:18432
ds_read_b64_tr_b16 a[142:143], v22 offset:18944
v_fma_f32 v142, v128, v144, v46
buffer_load_dwordx4 v12, s[24:27], s12 offen offset:1024 lds
v_fma_f32 v143, v128, v145, v62
v_fma_f32 v142, -v129, v145, v142
v_fmac_f32 v143, v129, v144
s_waitcnt lgkmcnt(8)
v_mfma_f32_32x32x16_bf16 v[96:111], a[152:155], a[28:31], v[96:111]
ds_read_b64_tr_b16 a[144:145], v21 offset:20480
ds_read_b64_tr_b16 a[146:147], v21 offset:20992
v_fma_f32 v144, v128, v142, v47
v_fma_f32 v145, v128, v143, v63
v_fma_f32 v144, -v129, v143, v144
v_fmac_f32 v145, v129, v142
v_mfma_f32_32x32x16_bf16 v[112:127], a[156:159], a[28:31], v[112:127]
ds_read_b64_tr_b16 a[148:149], v22 offset:20480
ds_read_b64_tr_b16 a[150:151], v22 offset:20992
s_add_u32 m0, s20, 57344
s_mul_i32 s12, s8, s30
s_add_u32 s12, s12, s21
s_add_u32 s8, s8, 1
s_and_b32 s8, s8, 7
buffer_load_dwordx4 v11, s[24:27], s12 offen offset:0 lds
ds_write_b64 v150, v[144:145] offset:1792
s_add_u32 s92, s31, 0xd00000
s_mov_b64 exec, 1
buffer_store_dword v154, off, s[76:79], s92 sc1
s_mov_b64 exec, -1
s_waitcnt lgkmcnt(9)
v_mfma_f32_32x32x16_bf16 v[96:111], a[128:131], a[32:35], v[96:111]
ds_read_b64_tr_b16 a[152:153], v21 offset:22528
ds_read_b64_tr_b16 a[154:155], v21 offset:23040
v_mfma_f32_32x32x16_bf16 v[112:127], a[132:135], a[32:35], v[112:127]
buffer_load_dwordx4 v12, s[24:27], s12 offen offset:1024 lds
ds_read_b64_tr_b16 a[156:157], v22 offset:22528
ds_read_b64_tr_b16 a[158:159], v22 offset:23040
s_waitcnt lgkmcnt(4)
s_barrier
v_mfma_f32_32x32x16_bf16 v[96:111], a[136:139], a[36:39], v[96:111]
ds_read_b64_tr_b16 a[128:129], v21 offset:24576
ds_read_b64_tr_b16 a[130:131], v21 offset:25088
ds_read_b64 v[160:161], v150 offset:0
ds_read_b64 v[162:163], v150 offset:256
ds_read_b64 v[164:165], v150 offset:512
ds_read_b64 v[166:167], v150 offset:768
s_add_u32 m0, s90, 73728
s_lshl_b32 s12, s37, 16
s_lshl_b32 s13, s7, 7
s_add_u32 s12, s12, s13
buffer_load_dwordx4 v4, s[64:67], s12 offen offset:0 lds
ds_read_b64 v[168:169], v150 offset:1024
ds_read_b64 v[170:171], v150 offset:1280
ds_read_b64 v[172:173], v150 offset:1536
v_mul_f32 v1, v139, v32
v_mfma_f32_32x32x16_bf16 v[112:127], a[140:143], a[36:39], v[112:127]
ds_read_b64_tr_b16 a[132:133], v22 offset:24576
ds_read_b64_tr_b16 a[134:135], v22 offset:25088
v_mul_f32 v32, v138, v32
v_fma_f32 v32, -v139, v48, v32
v_fma_f32 v48, v138, v48, v1
buffer_load_dwordx4 v5, s[64:67], s12 offen offset:1024 lds
v_mfma_f32_32x32x16_bf16 v[96:111], a[144:147], a[40:43], v[96:111]
ds_read_b64_tr_b16 a[136:137], v21 offset:26624
ds_read_b64_tr_b16 a[138:139], v21 offset:27136
v_mul_f32 v1, v139, v33
v_mul_f32 v33, v138, v33
v_mfma_f32_32x32x16_bf16 v[112:127], a[148:151], a[40:43], v[112:127]
ds_read_b64_tr_b16 a[140:141], v22 offset:26624
ds_read_b64_tr_b16 a[142:143], v22 offset:27136
v_fma_f32 v33, -v139, v49, v33
v_fma_f32 v49, v138, v49, v1
s_waitcnt lgkmcnt(6)
v_mfma_f32_32x32x16_bf16 v[96:111], a[152:155], a[44:47], v[96:111]
buffer_load_dwordx4 v6, s[64:67], s12 offen offset:2048 lds
ds_read_b64_tr_b16 a[144:145], v21 offset:28672
ds_read_b64_tr_b16 a[146:147], v21 offset:29184
v_fma_f32 v146, v130, v160, v162
v_fma_f32 v147, v130, v161, v163
v_mfma_f32_32x32x16_bf16 v[112:127], a[156:159], a[44:47], v[112:127]
ds_read_b64_tr_b16 a[148:149], v22 offset:28672
ds_read_b64_tr_b16 a[150:151], v22 offset:29184
v_fma_f32 v146, -v131, v161, v146
v_fmac_f32 v147, v131, v160
v_fma_f32 v140, v130, v146, v164
s_waitcnt lgkmcnt(8)
v_mfma_f32_32x32x16_bf16 v[96:111], a[128:131], a[48:51], v[96:111]
buffer_load_dwordx4 v7, s[64:67], s12 offen offset:3072 lds
ds_read_b64_tr_b16 a[152:153], v21 offset:30720
ds_read_b64_tr_b16 a[154:155], v21 offset:31232
v_fma_f32 v141, v130, v147, v165
v_fma_f32 v140, -v131, v147, v140
v_mfma_f32_32x32x16_bf16 v[112:127], a[132:135], a[48:51], v[112:127]
ds_read_b64_tr_b16 a[156:157], v22 offset:30720
ds_read_b64_tr_b16 a[158:159], v22 offset:31232
v_fmac_f32 v141, v131, v146
v_fma_f32 v146, v130, v140, v166
v_fma_f32 v147, v130, v141, v167
s_waitcnt lgkmcnt(8)
v_mfma_f32_32x32x16_bf16 v[96:111], a[136:139], a[52:55], v[96:111]
s_waitcnt vmcnt(9)
s_barrier
ds_read_b64_tr_b16 a[128:129], v21 offset:32768
s_add_u32 m0, s90, 77824
s_add_u32 s12, s12, 32768
buffer_load_dwordx4 v4, s[64:67], s12 offen offset:0 lds
ds_read_b64_tr_b16 a[130:131], v21 offset:33280
v_fma_f32 v146, -v131, v141, v146
v_fmac_f32 v147, v131, v140
v_mfma_f32_32x32x16_bf16 v[112:127], a[140:143], a[52:55], v[112:127]
ds_read_b64_tr_b16 a[132:133], v22 offset:32768
ds_read_b64_tr_b16 a[134:135], v22 offset:33280
v_fma_f32 v140, v130, v146, v168
v_fma_f32 v141, v130, v147, v169
v_fma_f32 v140, -v131, v147, v140
s_waitcnt lgkmcnt(8)
v_mfma_f32_32x32x16_bf16 v[96:111], a[144:147], a[56:59], v[96:111]
ds_read_b64_tr_b16 a[136:137], v21 offset:34816
buffer_load_dwordx4 v5, s[64:67], s12 offen offset:1024 lds
ds_read_b64_tr_b16 a[138:139], v21 offset:35328
v_fmac_f32 v141, v131, v146
v_fma_f32 v146, v130, v140, v170
v_mfma_f32_32x32x16_bf16 v[112:127], a[148:151], a[56:59], v[112:127]
ds_read_b64_tr_b16 a[140:141], v22 offset:34816
ds_read_b64_tr_b16 a[142:143], v22 offset:35328
v_fma_f32 v147, v130, v141, v171
v_fma_f32 v146, -v131, v141, v146
v_fmac_f32 v147, v131, v140
s_waitcnt lgkmcnt(8)
v_mfma_f32_32x32x16_bf16 v[96:111], a[152:155], a[60:63], v[96:111]
ds_read_b64_tr_b16 a[144:145], v21 offset:36864
ds_read_b64_tr_b16 a[146:147], v21 offset:37376
buffer_load_dwordx4 v6, s[64:67], s12 offen offset:2048 lds
v_fma_f32 v140, v130, v146, v172
v_fma_f32 v141, v130, v147, v173
v_mfma_f32_32x32x16_bf16 v[112:127], a[156:159], a[60:63], v[112:127]
ds_read_b64_tr_b16 a[148:149], v22 offset:36864
ds_read_b64_tr_b16 a[150:151], v22 offset:37376
v_fma_f32 v140, -v131, v147, v140
v_fmac_f32 v141, v131, v146
v_fma_f32 v152, v130, v140, v144
s_waitcnt lgkmcnt(8)
v_mfma_f32_32x32x16_bf16 v[96:111], a[128:131], a[64:67], v[96:111]
ds_read_b64_tr_b16 a[152:153], v21 offset:38912
ds_read_b64_tr_b16 a[154:155], v21 offset:39424
ds_read_b64_tr_b16 a[160:161], v23 offset:0
ds_read_b64_tr_b16 a[162:163], v23 offset:1024
buffer_load_dwordx4 v7, s[64:67], s12 offen offset:3072 lds
v_fma_f32 v153, v130, v141, v145
v_fma_f32 v152, -v131, v141, v152
v_mfma_f32_32x32x16_bf16 v[112:127], a[132:135], a[64:67], v[112:127]
ds_read_b64_tr_b16 a[156:157], v22 offset:38912
ds_read_b64_tr_b16 a[158:159], v22 offset:39424
ds_read_b64_tr_b16 a[164:165], v24 offset:0
ds_read_b64_tr_b16 a[166:167], v24 offset:1024
v_fmac_f32 v153, v131, v140
s_cmp_lg_u32 s3, 3
s_cbranch_scc1 L_noagg
s_lshl_b32 s92, s5, 4
s_add_u32 s92, s92, 15
s_sub_u32 s92, s92, s4
s_lshl_b32 s92, s92, 9
s_add_u32 s92, s92, 0xd60000
s_mov_b32 exec_lo, 0
buffer_store_dwordx4 v[152:155], v151, s[76:79], s92 offen sc1
s_mov_b64 exec, -1
L_noagg:
v_mul_f32 v1, v139, v34
s_waitcnt lgkmcnt(12)
v_mfma_f32_32x32x16_bf16 v[96:111], a[136:139], a[68:71], v[96:111]
ds_read_b64_tr_b16 a[128:129], v21 offset:40960
ds_read_b64_tr_b16 a[130:131], v21 offset:41472
ds_read_b64_tr_b16 a[168:169], v23 offset:2048
ds_read_b64_tr_b16 a[170:171], v23 offset:3072
v_mul_f32 v34, v138, v34
v_fma_f32 v34, -v139, v50, v34
v_mfma_f32_32x32x16_bf16 v[112:127], a[140:143], a[68:71], v[112:127]
ds_read_b64_tr_b16 a[132:133], v22 offset:40960
ds_read_b64_tr_b16 a[134:135], v22 offset:41472
ds_read_b64_tr_b16 a[172:173], v24 offset:2048
ds_read_b64_tr_b16 a[174:175], v24 offset:3072
v_fma_f32 v50, v138, v50, v1
v_mul_f32 v1, v139, v35
v_mul_f32 v35, v138, v35
s_waitcnt lgkmcnt(15)
v_mfma_f32_32x32x16_bf16 v[96:111], a[144:147], a[72:75], v[96:111]
ds_read_b64_tr_b16 a[136:137], v21 offset:43008
ds_read_b64_tr_b16 a[138:139], v21 offset:43520
ds_read_b64_tr_b16 a[176:177], v23 offset:4096
ds_read_b64_tr_b16 a[178:179], v23 offset:5120
v_fma_f32 v35, -v139, v51, v35
v_fma_f32 v51, v138, v51, v1
v_mfma_f32_32x32x16_bf16 v[112:127], a[148:151], a[72:75], v[112:127]
ds_read_b64_tr_b16 a[140:141], v22 offset:43008
ds_read_b64_tr_b16 a[142:143], v22 offset:43520
ds_read_b64_tr_b16 a[180:181], v24 offset:4096
ds_read_b64_tr_b16 a[182:183], v24 offset:5120
v_mul_f32 v1, v139, v36
v_mul_f32 v36, v138, v36
v_fma_f32 v36, -v139, v52, v36
s_waitcnt lgkmcnt(15)
v_mfma_f32_32x32x16_bf16 v[96:111], a[152:155], a[76:79], v[96:111]
ds_read_b64_tr_b16 a[144:145], v21 offset:45056
ds_read_b64_tr_b16 a[146:147], v21 offset:45568
ds_read_b64_tr_b16 a[184:185], v23 offset:6144
ds_read_b64_tr_b16 a[186:187], v23 offset:7168
v_fma_f32 v52, v138, v52, v1
v_mul_f32 v1, v139, v37
v_mfma_f32_32x32x16_bf16 v[112:127], a[156:159], a[76:79], v[112:127]
ds_read_b64_tr_b16 a[148:149], v22 offset:45056
ds_read_b64_tr_b16 a[150:151], v22 offset:45568
ds_read_b64_tr_b16 a[188:189], v24 offset:6144
ds_read_b64_tr_b16 a[190:191], v24 offset:7168
v_mul_f32 v37, v138, v37
v_fma_f32 v37, -v139, v53, v37
v_fma_f32 v53, v138, v53, v1
s_waitcnt lgkmcnt(15)
v_mfma_f32_32x32x16_bf16 v[96:111], a[128:131], a[80:83], v[96:111]
ds_read_b64_tr_b16 a[152:153], v21 offset:47104
ds_read_b64_tr_b16 a[154:155], v21 offset:47616
v_mul_f32 v1, v139, v38
v_mul_f32 v38, v138, v38
v_mfma_f32_32x32x16_bf16 v[112:127], a[132:135], a[80:83], v[112:127]
ds_read_b64_tr_b16 a[156:157], v22 offset:47104
ds_read_b64_tr_b16 a[158:159], v22 offset:47616
v_fma_f32 v38, -v139, v54, v38
v_fma_f32 v54, v138, v54, v1
v_mul_f32 v1, v139, v39
s_waitcnt lgkmcnt(4)
v_mfma_f32_32x32x16_bf16 v[96:111], a[136:139], a[84:87], v[96:111]
s_add_u32 m0, s90, 65536
s_lshl_b32 s12, s38, 16
s_lshl_b32 s13, s7, 7
s_add_u32 s12, s12, s13
buffer_load_dwordx4 v4, s[64:67], s12 offen offset:0 lds
buffer_load_dwordx4 v5, s[64:67], s12 offen offset:1024 lds
buffer_load_dwordx4 v6, s[64:67], s12 offen offset:2048 lds
s_waitcnt vmcnt(11)
s_barrier
ds_read_b64_tr_b16 a[128:129], v21 offset:49152
ds_read_b64_tr_b16 a[130:131], v21 offset:49664
v_mul_f32 v39, v138, v39
v_fma_f32 v39, -v139, v55, v39
v_mfma_f32_32x32x16_bf16 v[112:127], a[140:143], a[84:87], v[112:127]
ds_read_b64_tr_b16 a[132:133], v22 offset:49152
ds_read_b64_tr_b16 a[134:135], v22 offset:49664
v_fma_f32 v55, v138, v55, v1
v_mul_f32 v1, v139, v40
v_mul_f32 v40, v138, v40
v_mfma_f32_32x32x16_bf16 v[96:111], a[144:147], a[88:91], v[96:111]
buffer_load_dwordx4 v7, s[64:67], s12 offen offset:3072 lds
ds_read_b64_tr_b16 a[136:137], v21 offset:51200
ds_read_b64_tr_b16 a[138:139], v21 offset:51712
v_fma_f32 v40, -v139, v56, v40
v_fma_f32 v56, v138, v56, v1
v_mfma_f32_32x32x16_bf16 v[112:127], a[148:151], a[88:91], v[112:127]
ds_read_b64_tr_b16 a[140:141], v22 offset:51200
ds_read_b64_tr_b16 a[142:143], v22 offset:51712
v_mul_f32 v1, v139, v41
v_mul_f32 v41, v138, v41
v_fma_f32 v41, -v139, v57, v41
s_waitcnt lgkmcnt(8)
v_mfma_f32_32x32x16_bf16 v[96:111], a[152:155], a[92:95], v[96:111]
ds_read_b64_tr_b16 a[144:145], v21 offset:53248
ds_read_b64_tr_b16 a[146:147], v21 offset:53760
s_add_u32 m0, s90, 69632
s_add_u32 s12, s12, 32768
buffer_load_dwordx4 v4, s[64:67], s12 offen offset:0 lds
v_fma_f32 v57, v138, v57, v1
v_mul_f32 v1, v139, v42
v_mfma_f32_32x32x16_bf16 v[112:127], a[156:159], a[92:95], v[112:127]
ds_read_b64_tr_b16 a[148:149], v22 offset:53248
ds_read_b64_tr_b16 a[150:151], v22 offset:53760
v_mul_f32 v42, v138, v42
v_fma_f32 v42, -v139, v58, v42
v_fma_f32 v58, v138, v58, v1
s_waitcnt lgkmcnt(8)
v_mfma_f32_32x32x16_bf16 v[96:111], a[128:131], a[96:99], v[96:111]
ds_read_b64_tr_b16 a[152:153], v21 offset:55296
ds_read_b64_tr_b16 a[154:155], v21 offset:55808
buffer_load_dwordx4 v5, s[64:67], s12 offen offset:1024 lds
v_mul_f32 v1, v139, v43
v_mul_f32 v43, v138, v43
v_mfma_f32_32x32x16_bf16 v[112:127], a[132:135], a[96:99], v[112:127]
ds_read_b64_tr_b16 a[156:157], v22 offset:55296
ds_read_b64_tr_b16 a[158:159], v22 offset:55808
v_fma_f32 v43, -v139, v59, v43
v_fma_f32 v59, v138, v59, v1
v_mul_f32 v1, v139, v44
s_waitcnt lgkmcnt(8)
v_mfma_f32_32x32x16_bf16 v[96:111], a[136:139], a[100:103], v[96:111]
ds_read_b64_tr_b16 a[128:129], v21 offset:57344
ds_read_b64_tr_b16 a[130:131], v21 offset:57856
v_mul_f32 v44, v138, v44
buffer_load_dwordx4 v6, s[64:67], s12 offen offset:2048 lds
v_fma_f32 v44, -v139, v60, v44
v_mfma_f32_32x32x16_bf16 v[112:127], a[140:143], a[100:103], v[112:127]
ds_read_b64_tr_b16 a[132:133], v22 offset:57344
ds_read_b64_tr_b16 a[134:135], v22 offset:57856
v_fma_f32 v60, v138, v60, v1
v_mul_f32 v1, v139, v45
v_mul_f32 v45, v138, v45
s_add_u32 s60, s45, 0xd00000
s_load_dwordx8 s[52:59], s[76:77], s60 glc
s_waitcnt lgkmcnt(8)
v_mfma_f32_32x32x16_bf16 v[96:111], a[144:147], a[104:107], v[96:111]
ds_read_b64_tr_b16 a[136:137], v21 offset:59392
ds_read_b64_tr_b16 a[138:139], v21 offset:59904
v_fma_f32 v45, -v139, v61, v45
buffer_load_dwordx4 v7, s[64:67], s12 offen offset:3072 lds
v_fma_f32 v61, v138, v61, v1
v_mfma_f32_32x32x16_bf16 v[112:127], a[148:151], a[104:107], v[112:127]
ds_read_b64_tr_b16 a[140:141], v22 offset:59392
ds_read_b64_tr_b16 a[142:143], v22 offset:59904
v_mul_f32 v1, v139, v46
v_mul_f32 v46, v138, v46
v_fma_f32 v46, -v139, v62, v46
s_waitcnt lgkmcnt(8)
v_mfma_f32_32x32x16_bf16 v[96:111], a[152:155], a[108:111], v[96:111]
ds_read_b64_tr_b16 a[144:145], v21 offset:61440
ds_read_b64_tr_b16 a[146:147], v21 offset:61952
v_fma_f32 v62, v138, v62, v1
v_mul_f32 v1, v139, v47
s_add_u32 m0, s46, 0
s_lshl_b32 s12, s39, 16
s_lshl_b32 s13, s7, 7
s_add_u32 s12, s12, s13
buffer_load_dwordx4 v4, s[64:67], s12 offen offset:0 lds
v_mfma_f32_32x32x16_bf16 v[112:127], a[156:159], a[108:111], v[112:127]
ds_read_b64_tr_b16 a[148:149], v22 offset:61440
ds_read_b64_tr_b16 a[150:151], v22 offset:61952
v_mul_f32 v47, v138, v47
v_fma_f32 v47, -v139, v63, v47
v_fma_f32 v63, v138, v63, v1
s_waitcnt lgkmcnt(8)
v_mfma_f32_32x32x16_bf16 v[96:111], a[128:131], a[112:115], v[96:111]
ds_read_b64_tr_b16 a[152:153], v21 offset:63488
ds_read_b64_tr_b16 a[154:155], v21 offset:64000
v_mfma_f32_32x32x16_bf16 v[112:127], a[132:135], a[112:115], v[112:127]
buffer_load_dwordx4 v5, s[64:67], s12 offen offset:1024 lds
ds_read_b64_tr_b16 a[156:157], v22 offset:63488
ds_read_b64_tr_b16 a[158:159], v22 offset:64000
buffer_load_dwordx4 v[176:179], v158, s[84:87], 0 offen offset:0 sc1
buffer_load_dwordx4 v[180:183], v158, s[84:87], 0 offen offset:512 sc1
s_waitcnt lgkmcnt(8)
v_mfma_f32_32x32x16_bf16 v[96:111], a[136:139], a[116:119], v[96:111]
v_mfma_f32_32x32x16_bf16 v[112:127], a[140:143], a[116:119], v[112:127]
s_waitcnt lgkmcnt(4)
v_mfma_f32_32x32x16_bf16 v[96:111], a[144:147], a[120:123], v[96:111]
v_mfma_f32_32x32x16_bf16 v[112:127], a[148:151], a[120:123], v[112:127]
s_waitcnt lgkmcnt(0)
v_mfma_f32_32x32x16_bf16 v[96:111], a[152:155], a[124:127], v[96:111]
v_mfma_f32_32x32x16_bf16 v[112:127], a[156:159], a[124:127], v[112:127]
buffer_load_dwordx4 v6, s[64:67], s12 offen offset:2048 lds
s_lshr_b32 s92, s3, 1
s_lshl_b32 s93, s6, 1
s_add_u32 s92, s92, s93
s_lshl_b32 s99, s92, 15
s_mul_i32 s91, s6, 360448
s_and_b32 s92, s92, 1
s_lshl_b32 s92, s92, 9
s_xor_b32 s89, s92, 512
s_add_u32 s89, s89, s91
s_add_u32 s91, s91, s92
s_waitcnt lgkmcnt(0)
s_and_b64 s[62:63], s[52:53], s[54:55]
s_or_b64 s[52:53], s[52:53], s[54:55]
s_and_b64 s[54:55], s[56:57], s[58:59]
s_or_b64 s[56:57], s[56:57], s[58:59]
s_and_b64 s[62:63], s[62:63], s[54:55]
s_or_b64 s[52:53], s[52:53], s[56:57]
s_and_b32 s62, s62, s63
s_or_b32 s52, s52, s53
s_xor_b32 s62, s62, s10
s_xor_b32 s52, s52, s10
s_or_b32 s52, s52, s62
s_cbranch_scc0 L_f0_ok
s_mov_b32 s98, 20000
L_f0_loop:
s_load_dwordx8 s[52:59], s[76:77], s60 glc
s_waitcnt lgkmcnt(0)
s_and_b64 s[62:63], s[52:53], s[54:55]
s_or_b64 s[52:53], s[52:53], s[54:55]
s_and_b64 s[54:55], s[56:57], s[58:59]
s_or_b64 s[56:57], s[56:57], s[58:59]
s_and_b64 s[62:63], s[62:63], s[54:55]
s_or_b64 s[52:53], s[52:53], s[56:57]
s_and_b32 s62, s62, s63
s_or_b32 s52, s52, s53
s_xor_b32 s62, s62, s10
s_xor_b32 s52, s52, s10
s_or_b32 s52, s52, s62
s_cbranch_scc0 L_f0_ok
s_sub_u32 s98, s98, 1
s_cmp_lg_u32 s98, 0
s_cbranch_scc1 L_f0_loop
L_f0_ok:
v_add_f32 v28, v96, v101
s_mul_i32 s43, s34, 8192
s_add_u32 s42, s43, s91
s_add_u32 s43, s43, s89
buffer_load_dwordx4 a[0:3], v31, s[76:79], s42 offen offset:0 sc1
buffer_load_dwordx4 a[4:7], v31, s[76:79], s43 offen offset:0 sc1
buffer_load_dwordx4 a[8:11], v31, s[76:79], s42 offen offset:128 sc1
buffer_load_dwordx4 a[12:15], v31, s[76:79], s43 offen offset:128 sc1
buffer_load_dwordx4 a[16:19], v31, s[76:79], s42 offen offset:256 sc1
buffer_load_dwordx4 a[20:23], v31, s[76:79], s43 offen offset:256 sc1
v_cvt_pk_bf16_f32 v96, v96, v97
v_cvt_pk_bf16_f32 v97, v98, v99
v_cvt_pk_bf16_f32 v98, v100, v101
buffer_load_dwordx4 a[24:27], v31, s[76:79], s42 offen offset:384 sc1
v_cvt_pk_bf16_f32 v99, v102, v103
v_pk_max_i16 v96, v96, 0
v_pk_max_i16 v97, v97, 0
buffer_load_dwordx4 a[28:31], v31, s[76:79], s43 offen offset:384 sc1
v_pk_max_i16 v98, v98, 0
v_pk_max_i16 v99, v99, 0
v_cvt_pk_bf16_f32 v104, v104, v105
s_mul_i32 s43, s35, 8192
s_add_u32 s42, s43, s91
s_add_u32 s43, s43, s89
buffer_load_dwordx4 a[32:35], v31, s[76:79], s42 offen offset:0 sc1
v_cvt_pk_bf16_f32 v105, v106, v107
v_cvt_pk_bf16_f32 v106, v108, v109
v_cvt_pk_bf16_f32 v107, v110, v111
buffer_load_dwordx4 a[36:39], v31, s[76:79], s43 offen offset:0 sc1
v_pk_max_i16 v104, v104, 0
v_pk_max_i16 v105, v105, 0
v_pk_max_i16 v106, v106, 0
buffer_load_dwordx4 a[40:43], v31, s[76:79], s42 offen offset:128 sc1
v_pk_max_i16 v107, v107, 0
v_cvt_pk_bf16_f32 v112, v112, v113
v_cvt_pk_bf16_f32 v113, v114, v115
buffer_load_dwordx4 a[44:47], v31, s[76:79], s43 offen offset:128 sc1
v_cvt_pk_bf16_f32 v114, v116, v117
v_cvt_pk_bf16_f32 v115, v118, v119
v_pk_max_i16 v112, v112, 0
v_pk_max_i16 v113, v113, 0
v_pk_max_i16 v114, v114, 0
v_pk_max_i16 v115, v115, 0
v_cvt_pk_bf16_f32 v120, v120, v121
v_cvt_pk_bf16_f32 v121, v122, v123
v_cvt_pk_bf16_f32 v122, v124, v125
v_cvt_pk_bf16_f32 v123, v126, v127
v_pk_max_i16 v120, v120, 0
v_pk_max_i16 v121, v121, 0
v_pk_max_i16 v122, v122, 0
v_pk_max_i16 v123, v123, 0
buffer_store_dwordx4 v[96:99], v25, s[76:79], s97 offen offset:0 sc1
buffer_store_dwordx4 v[104:107], v25, s[76:79], s97 offen offset:128 sc1
buffer_store_dwordx4 v[112:115], v25, s[76:79], s97 offen offset:256 sc1
buffer_store_dwordx4 v[120:123], v25, s[76:79], s97 offen offset:384 sc1
s_lshr_b32 s92, s88, 8
s_lshr_b32 s93, s5, 2
s_lshl_b32 s93, s93, 13
s_add_u32 s92, s92, s93
s_add_u32 s92, s92, 0xd80000
s_cmp_eq_u32 s30, 128
s_cselect_b32 s93, 0, 0x40000000
v_add_u32 v157, s93, v157
s_mov_b32 exec_hi, 0
buffer_store_dword v28, v157, s[76:79], s92 offen sc1
s_mov_b64 exec, -1
s_waitcnt vmcnt(18)
v_mov_b32 v146, 0
v_cmp_eq_u64 vcc, s[10:11], v[178:179]
s_nop 1
v_addc_co_u32 v146, vcc, 0, v146, vcc
v_cmp_eq_u64 vcc, s[10:11], v[182:183]
s_nop 1
v_addc_co_u32 v146, vcc, 0, v146, vcc
v_cmp_ne_u32 vcc, v146, v159
s_nop 1
s_cbranch_vccz L_ag_ok
s_mov_b32 s98, 20000
L_ag_loop:
s_sleep 1
buffer_load_dwordx4 v[176:179], v158, s[84:87], 0 offen offset:0 sc1
buffer_load_dwordx4 v[180:183], v158, s[84:87], 0 offen offset:512 sc1
s_waitcnt vmcnt(0)
v_mov_b32 v146, 0
v_cmp_eq_u64 vcc, s[10:11], v[178:179]
s_nop 1
v_addc_co_u32 v146, vcc, 0, v146, vcc
v_cmp_eq_u64 vcc, s[10:11], v[182:183]
s_nop 1
v_addc_co_u32 v146, vcc, 0, v146, vcc
v_cmp_ne_u32 vcc, v146, v159
s_nop 1
s_cbranch_vccz L_ag_ok
s_sub_u32 s98, s98, 1
s_cmp_lg_u32 s98, 0
s_cbranch_scc1 L_ag_loop
L_ag_ok:
v_fma_f32 v142, v134, v180, v176
v_fma_f32 v143, v134, v181, v177
v_fma_f32 v142, -v135, v181, v142
v_fmac_f32 v143, v135, v180
v_mul_f32 v144, v136, v142
v_mul_f32 v145, v136, v143
v_fma_f32 v144, -v137, v143, v144
v_fmac_f32 v145, v137, v142
ds_write_b64 v150, v[144:145] offset:24576
v_and_b32 v152, 31, v0
v_lshlrev_b32 v146, 3, v152
v_add_u32 v146, 155648, v146
s_mul_i32 s94, s3, 4608
s_add_u32 s94, s94, 135168
v_mul_u32_u24 v152, 72, v152
v_lshrrev_b32 v2, 5, v0
s_waitcnt lgkmcnt(0)
s_barrier
ds_read_b64 v[176:177], v146 offset:0
ds_read_b64 v[178:179], v146 offset:256
ds_read_b64 v[180:181], v146 offset:512
ds_read_b64 v[182:183], v146 offset:768
ds_read_b64 v[184:185], v146 offset:1024
ds_read_b64 v[186:187], v146 offset:1280
ds_read_b64 v[188:189], v146 offset:1536
ds_read_b64 v[190:191], v146 offset:1792
s_waitcnt vmcnt(15)
v_mfma_f32_32x32x16_bf16 v[64:79], a[0:3], a[192:195], 0
buffer_load_dwordx4 a[48:51], v31, s[76:79], s42 offen offset:256 sc1
s_waitcnt lgkmcnt(0)
v_add_f32 v176, v176, v178
v_add_f32 v177, v177, v179
v_add_f32 v180, v180, v182
v_add_f32 v181, v181, v183
v_mfma_f32_32x32x16_bf16 v[80:95], a[0:3], a[196:199], 0
buffer_load_dwordx4 a[52:55], v31, s[76:79], s43 offen offset:256 sc1
v_add_f32 v184, v184, v186
v_add_f32 v185, v185, v187
v_add_f32 v188, v188, v190
v_add_f32 v189, v189, v191
v_add_f32 v176, v176, v180
v_mfma_f32_32x32x16_bf16 v[96:111], a[4:7], a[192:195], 0
v_add_f32 v177, v177, v181
v_add_f32 v184, v184, v188
v_add_f32 v185, v185, v189
v_add_f32 v176, v176, v184
v_add_f32 v177, v177, v185
v_mfma_f32_32x32x16_bf16 v[112:127], a[4:7], a[196:199], 0
v_fma_f32 v142, v132, v176, v140
v_fma_f32 v143, v132, v177, v141
v_fma_f32 v142, -v133, v177, v142
v_fmac_f32 v143, v133, v176
v_mul_f32 v144, v138, v142
s_waitcnt vmcnt(15)
v_mfma_f32_32x32x16_bf16 v[64:79], a[8:11], a[200:203], v[64:79]
buffer_load_dwordx4 a[56:59], v31, s[76:79], s42 offen offset:384 sc1
v_mul_f32 v145, v138, v143
v_fma_f32 v144, -v139, v143, v144
v_fmac_f32 v145, v139, v142
v_lshl_add_u32 v152, v2, 3, v152
v_add_u32 v152, s94, v152
v_mfma_f32_32x32x16_bf16 v[80:95], a[8:11], a[204:207], v[80:95]
buffer_load_dwordx4 a[60:63], v31, s[76:79], s43 offen offset:384 sc1
v_fmac_f32 v32, v128, v144
v_fmac_f32 v48, v128, v145
v_fma_f32 v32, -v129, v145, v32
v_fmac_f32 v48, v129, v144
v_fmac_f32 v33, v128, v32
v_mfma_f32_32x32x16_bf16 v[96:111], a[12:15], a[200:203], v[96:111]
v_fmac_f32 v49, v128, v48
v_fma_f32 v33, -v129, v48, v33
v_fmac_f32 v49, v129, v32
v_fmac_f32 v34, v128, v33
v_fmac_f32 v50, v128, v49
v_mfma_f32_32x32x16_bf16 v[112:127], a[12:15], a[204:207], v[112:127]
v_fma_f32 v34, -v129, v49, v34
v_fmac_f32 v50, v129, v33
v_fmac_f32 v35, v128, v34
v_fmac_f32 v51, v128, v50
v_fma_f32 v35, -v129, v50, v35
s_waitcnt vmcnt(15)
v_mfma_f32_32x32x16_bf16 v[64:79], a[16:19], a[208:211], v[64:79]
s_mul_i32 s43, s36, 8192
s_add_u32 s42, s43, s91
s_add_u32 s43, s43, s89
buffer_load_dwordx4 a[64:67], v31, s[76:79], s42 offen offset:0 sc1
v_fmac_f32 v51, v129, v34
v_cvt_pk_bf16_f32 v160, v32, v33
v_cvt_pk_bf16_f32 v161, v34, v35
v_cvt_pk_bf16_f32 v162, -v48, -v49
v_cvt_pk_bf16_f32 v163, -v50, -v51
v_mfma_f32_32x32x16_bf16 v[80:95], a[16:19], a[212:215], v[80:95]
buffer_load_dwordx4 a[68:71], v31, s[76:79], s43 offen offset:0 sc1
ds_write_b64 v152, v[160:161] offset:0
ds_write_b64 v152, v[162:163] offset:2304
v_fmac_f32 v36, v128, v35
v_fmac_f32 v52, v128, v51
v_fma_f32 v36, -v129, v51, v36
v_fmac_f32 v52, v129, v35
v_mfma_f32_32x32x16_bf16 v[96:111], a[20:23], a[208:211], v[96:111]
v_fmac_f32 v37, v128, v36
v_fmac_f32 v53, v128, v52
v_fma_f32 v37, -v129, v52, v37
v_fmac_f32 v53, v129, v36
v_fmac_f32 v38, v128, v37
v_mfma_f32_32x32x16_bf16 v[112:127], a[20:23], a[212:215], v[112:127]
v_fmac_f32 v54, v128, v53
v_fma_f32 v38, -v129, v53, v38
v_fmac_f32 v54, v129, v37
v_fmac_f32 v39, v128, v38
v_fmac_f32 v55, v128, v54
s_waitcnt vmcnt(6)
s_add_u32 s92, s31, 0xd20000
s_mov_b64 exec, 1
buffer_store_dword v154, off, s[76:79], s92 sc1
s_mov_b64 exec, -1
v_mfma_f32_32x32x16_bf16 v[64:79], a[24:27], a[216:219], v[64:79]
buffer_load_dwordx4 a[72:75], v31, s[76:79], s42 offen offset:128 sc1
v_fma_f32 v39, -v129, v54, v39
v_fmac_f32 v55, v129, v38
v_cvt_pk_bf16_f32 v164, v36, v37
v_cvt_pk_bf16_f32 v165, v38, v39
v_cvt_pk_bf16_f32 v166, -v52, -v53
v_mfma_f32_32x32x16_bf16 v[80:95], a[24:27], a[220:223], v[80:95]
buffer_load_dwordx4 a[76:79], v31, s[76:79], s43 offen offset:128 sc1
v_cvt_pk_bf16_f32 v167, -v54, -v55
ds_write_b64 v152, v[164:165] offset:16
ds_write_b64 v152, v[166:167] offset:2320
v_fmac_f32 v40, v128, v39
v_fmac_f32 v56, v128, v55
v_fma_f32 v40, -v129, v55, v40
v_mfma_f32_32x32x16_bf16 v[96:111], a[28:31], a[216:219], v[96:111]
v_fmac_f32 v56, v129, v39
v_fmac_f32 v41, v128, v40
v_fmac_f32 v57, v128, v56
v_fma_f32 v41, -v129, v56, v41
v_fmac_f32 v57, v129, v40
v_mfma_f32_32x32x16_bf16 v[112:127], a[28:31], a[220:223], v[112:127]
v_fmac_f32 v42, v128, v41
v_fmac_f32 v58, v128, v57
v_fma_f32 v42, -v129, v57, v42
v_fmac_f32 v58, v129, v41
v_fmac_f32 v43, v128, v42
v_mfma_f32_32x32x16_bf16 v[64:79], a[32:35], a[224:227], v[64:79]
buffer_load_dwordx4 a[80:83], v31, s[76:79], s42 offen offset:256 sc1
v_fmac_f32 v59, v128, v58
v_fma_f32 v43, -v129, v58, v43
v_fmac_f32 v59, v129, v42
v_cvt_pk_bf16_f32 v168, v40, v41
v_cvt_pk_bf16_f32 v169, v42, v43
v_mfma_f32_32x32x16_bf16 v[80:95], a[32:35], a[228:231], v[80:95]
buffer_load_dwordx4 a[84:87], v31, s[76:79], s43 offen offset:256 sc1
v_cvt_pk_bf16_f32 v170, -v56, -v57
v_cvt_pk_bf16_f32 v171, -v58, -v59
ds_write_b64 v152, v[168:169] offset:32
ds_write_b64 v152, v[170:171] offset:2336
v_fmac_f32 v44, v128, v43
v_fmac_f32 v60, v128, v59
v_mfma_f32_32x32x16_bf16 v[96:111], a[36:39], a[224:227], v[96:111]
v_fma_f32 v44, -v129, v59, v44
v_fmac_f32 v60, v129, v43
v_fmac_f32 v45, v128, v44
v_fmac_f32 v61, v128, v60
v_fma_f32 v45, -v129, v60, v45
v_mfma_f32_32x32x16_bf16 v[112:127], a[36:39], a[228:231], v[112:127]
v_fmac_f32 v61, v129, v44
v_fmac_f32 v46, v128, v45
v_fmac_f32 v62, v128, v61
v_fma_f32 v46, -v129, v61, v46
v_fmac_f32 v62, v129, v45
v_mfma_f32_32x32x16_bf16 v[64:79], a[40:43], a[232:235], v[64:79]
buffer_load_dwordx4 a[88:91], v31, s[76:79], s42 offen offset:384 sc1
v_fmac_f32 v47, v128, v46
v_fmac_f32 v63, v128, v62
v_fma_f32 v47, -v129, v62, v47
v_fmac_f32 v63, v129, v46
v_cvt_pk_bf16_f32 v172, v44, v45
v_mfma_f32_32x32x16_bf16 v[80:95], a[40:43], a[236:239], v[80:95]
buffer_load_dwordx4 a[92:95], v31, s[76:79], s43 offen offset:384 sc1
v_cvt_pk_bf16_f32 v173, v46, v47
v_cvt_pk_bf16_f32 v174, -v60, -v61
v_cvt_pk_bf16_f32 v175, -v62, -v63
ds_write_b64 v152, v[172:173] offset:48
ds_write_b64 v152, v[174:175] offset:2352
v_bfe_u32 v3, v0, 2, 2
v_mfma_f32_32x32x16_bf16 v[96:111], a[44:47], a[232:235], v[96:111]
v_lshl_add_u32 v153, v2, 3, v3
v_mul_u32_u24 v153, 72, v153
v_bfe_u32 v3, v0, 4, 1
v_lshl_add_u32 v153, v3, 5, v153
v_and_b32 v3, 3, v0
v_mfma_f32_32x32x16_bf16 v[112:127], a[44:47], a[236:239], v[112:127]
v_lshl_add_u32 v153, v3, 3, v153
v_add_u32 v153, s94, v153
s_waitcnt lgkmcnt(0)
ds_read_b64_tr_b16 v[176:177], v153 offset:0
ds_read_b64_tr_b16 v[178:179], v153 offset:288
ds_read_b64_tr_b16 v[180:181], v153 offset:1152
ds_read_b64_tr_b16 v[182:183], v153 offset:1440
ds_read_b64_tr_b16 v[184:185], v153 offset:2304
ds_read_b64_tr_b16 v[186:187], v153 offset:2592
ds_read_b64_tr_b16 v[188:189], v153 offset:3456
ds_read_b64_tr_b16 v[190:191], v153 offset:3744
s_and_b32 s94, s3, 1
s_lshl_b32 s94, s94, 12
s_add_u32 s94, s46, s94
s_add_u32 s95, s46, 0x10000
v_add_u32 v208, s94, v17
s_waitcnt vmcnt(11)
v_mfma_f32_32x32x16_bf16 v[64:79], a[48:51], a[240:243], v[64:79]
s_mul_i32 s43, s37, 8192
s_add_u32 s42, s43, s91
s_add_u32 s43, s43, s89
buffer_load_dwordx4 a[0:3], v31, s[76:79], s42 offen offset:0 sc1
v_xor_b32 v212, 0x1000, v208
v_add_u32 v216, s95, v208
v_add_u32 v220, s95, v212
v_add_u32 v209, s94, v18
v_xor_b32 v213, 0x1000, v209
v_mfma_f32_32x32x16_bf16 v[80:95], a[48:51], a[244:247], v[80:95]
buffer_load_dwordx4 a[4:7], v31, s[76:79], s43 offen offset:0 sc1
s_lshr_b32 s92, s5, 1
s_mul_i32 s92, s92, 16384
s_and_b32 s93, s5, 1
s_lshl_b32 s93, s93, 8
s_add_u32 s92, s92, s93
s_add_u32 s92, s92, s96
s_add_u32 s92, s92, 229376
s_add_u32 s93, s92, 8192
s_waitcnt lgkmcnt(0)
buffer_store_dwordx4 v[176:179], v31, s[76:79], s92 offen offset:0 sc1
buffer_store_dwordx4 v[180:183], v31, s[76:79], s92 offen offset:128 sc1
buffer_store_dwordx4 v[184:187], v31, s[76:79], s93 offen offset:0 sc1
buffer_store_dwordx4 v[188:191], v31, s[76:79], s93 offen offset:128 sc1
v_add_u32 v217, s95, v209
v_add_u32 v221, s95, v213
v_add_u32 v210, s94, v19
v_xor_b32 v214, 0x1000, v210
v_mfma_f32_32x32x16_bf16 v[96:111], a[52:55], a[240:243], v[96:111]
v_add_u32 v218, s95, v210
v_add_u32 v222, s95, v214
v_add_u32 v211, s94, v20
v_mfma_f32_32x32x16_bf16 v[112:127], a[52:55], a[244:247], v[112:127]
v_xor_b32 v215, 0x1000, v211
v_add_u32 v219, s95, v211
v_add_u32 v223, s95, v215
s_waitcnt vmcnt(15)
v_mfma_f32_32x32x16_bf16 v[64:79], a[56:59], a[248:251], v[64:79]
buffer_load_dwordx4 a[8:11], v31, s[76:79], s42 offen offset:128 sc1
v_mfma_f32_32x32x16_bf16 v[80:95], a[56:59], a[252:255], v[80:95]
buffer_load_dwordx4 a[12:15], v31, s[76:79], s43 offen offset:128 sc1
v_mfma_f32_32x32x16_bf16 v[96:111], a[60:63], a[248:251], v[96:111]
v_mfma_f32_32x32x16_bf16 v[112:127], a[60:63], a[252:255], v[112:127]
s_add_u32 s60, s45, 0xd20000
s_load_dwordx8 s[52:59], s[76:77], s60 glc
s_waitcnt vmcnt(15)
v_mfma_f32_32x32x16_bf16 v[64:79], a[64:67], a[160:163], v[64:79]
buffer_load_dwordx4 a[16:19], v31, s[76:79], s42 offen offset:256 sc1
v_mfma_f32_32x32x16_bf16 v[80:95], a[64:67], a[164:167], v[80:95]
buffer_load_dwordx4 a[20:23], v31, s[76:79], s43 offen offset:256 sc1
v_mfma_f32_32x32x16_bf16 v[96:111], a[68:71], a[160:163], v[96:111]
v_mfma_f32_32x32x16_bf16 v[112:127], a[68:71], a[164:167], v[112:127]
s_waitcnt vmcnt(14)
v_mfma_f32_32x32x16_bf16 v[64:79], a[72:75], a[168:171], v[64:79]
buffer_load_dwordx4 a[24:27], v31, s[76:79], s42 offen offset:384 sc1
s_and_b32 s93, s3, 1
s_lshl_b32 s94, s7, 1
s_add_u32 s93, s93, s94
s_lshl_b32 s93, s93, 6
s_add_u32 s88, s99, s93
v_and_b32 v2, 31, v0
v_lshl_add_u32 v151, v2, 1, s93
v_lshrrev_b32 v1, 2, v0
v_and_b32 v150, 3, v0
v_mfma_f32_32x32x16_bf16 v[80:95], a[72:75], a[172:175], v[80:95]
buffer_load_dwordx4 a[28:31], v31, s[76:79], s43 offen offset:384 sc1
v_lshlrev_b32 v150, 4, v150
v_lshl_add_u32 v150, v1, 10, v150
global_load_ushort v152, v151, s[32:33]
v_mfma_f32_32x32x16_bf16 v[96:111], a[76:79], a[168:171], v[96:111]
s_mul_i32 s94, s3, 4608
s_add_u32 s94, s94, 135168
v_lshl_add_u32 v153, v2, 1, s94
v_lshrrev_b32 v1, 5, v0
v_mfma_f32_32x32x16_bf16 v[112:127], a[76:79], a[172:175], v[112:127]
v_lshl_add_u32 v151, v1, 10, v153
s_waitcnt lgkmcnt(0)
s_and_b64 s[62:63], s[52:53], s[54:55]
s_or_b64 s[52:53], s[52:53], s[54:55]
s_and_b64 s[54:55], s[56:57], s[58:59]
s_or_b64 s[56:57], s[56:57], s[58:59]
s_and_b64 s[62:63], s[62:63], s[54:55]
s_or_b64 s[52:53], s[52:53], s[56:57]
s_and_b32 s62, s62, s63
s_or_b32 s52, s52, s53
s_xor_b32 s62, s62, s10
s_xor_b32 s52, s52, s10
s_or_b32 s52, s52, s62
s_cbranch_scc0 L_f1_ok
s_mov_b32 s98, 20000
L_f1_loop:
s_load_dwordx8 s[52:59], s[76:77], s60 glc
s_waitcnt lgkmcnt(0)
s_and_b64 s[62:63], s[52:53], s[54:55]
s_or_b64 s[52:53], s[52:53], s[54:55]
s_and_b64 s[54:55], s[56:57], s[58:59]
s_or_b64 s[56:57], s[56:57], s[58:59]
s_and_b64 s[62:63], s[62:63], s[54:55]
s_or_b64 s[52:53], s[52:53], s[56:57]
s_and_b32 s62, s62, s63
s_or_b32 s52, s52, s53
s_xor_b32 s62, s62, s10
s_xor_b32 s52, s52, s10
s_or_b32 s52, s52, s62
s_cbranch_scc0 L_f1_ok
s_sub_u32 s98, s98, 1
s_cmp_lg_u32 s98, 0
s_cbranch_scc1 L_f1_loop
L_f1_ok:
s_mul_i32 s43, s38, 8192
s_add_u32 s42, s43, s91
s_add_u32 s43, s43, s89
buffer_load_dwordx4 a[32:35], v31, s[76:79], s42 offen offset:0 sc1
buffer_load_dwordx4 a[36:39], v31, s[76:79], s43 offen offset:0 sc1
buffer_load_dwordx4 a[40:43], v31, s[76:79], s42 offen offset:128 sc1
buffer_load_dwordx4 a[44:47], v31, s[76:79], s43 offen offset:128 sc1
s_lshl_b32 s92, s6, 8
s_lshl_b32 s93, s3, 13
s_add_u32 s92, s92, s93
s_add_u32 s92, s92, 0xd80000
v_lshlrev_b32 v1, 2, v0
buffer_load_dword v28, v1, s[76:79], s92 offen sc1
s_waitcnt vmcnt(20)
v_mfma_f32_32x32x16_bf16 v[64:79], a[80:83], a[176:179], v[64:79]
ds_read_b64_tr_b16 a[96:97], v23 offset:8192
ds_read_b64_tr_b16 a[98:99], v23 offset:9216
ds_read_b64_tr_b16 a[100:101], v24 offset:8192
ds_read_b64_tr_b16 a[102:103], v24 offset:9216
v_mfma_f32_32x32x16_bf16 v[80:95], a[80:83], a[180:183], v[80:95]
v_mfma_f32_32x32x16_bf16 v[96:111], a[84:87], a[176:179], v[96:111]
v_mfma_f32_32x32x16_bf16 v[112:127], a[84:87], a[180:183], v[112:127]
s_waitcnt vmcnt(18)
v_mfma_f32_32x32x16_bf16 v[64:79], a[88:91], a[184:187], v[64:79]
ds_read_b64_tr_b16 a[104:105], v23 offset:10240
ds_read_b64_tr_b16 a[106:107], v23 offset:11264
ds_read_b64_tr_b16 a[108:109], v24 offset:10240
ds_read_b64_tr_b16 a[110:111], v24 offset:11264
buffer_load_dwordx4 v7, s[64:67], s12 offen offset:3072 lds
v_mfma_f32_32x32x16_bf16 v[80:95], a[88:91], a[188:191], v[80:95]
s_add_u32 m0, s46, 4096
s_add_u32 s12, s12, 32768
buffer_load_dwordx4 v4, s[64:67], s12 offen offset:0 lds
v_mfma_f32_32x32x16_bf16 v[96:111], a[92:95], a[184:187], v[96:111]
buffer_load_dwordx4 v5, s[64:67], s12 offen offset:1024 lds
v_mfma_f32_32x32x16_bf16 v[112:127], a[92:95], a[188:191], v[112:127]
buffer_load_dwordx4 v6, s[64:67], s12 offen offset:2048 lds
s_waitcnt vmcnt(16)
s_add_u32 s92, s31, 0xd40000
s_mov_b64 exec, 1
buffer_store_dword v154, off, s[76:79], s92 sc1
s_mov_b64 exec, -1
s_waitcnt lgkmcnt(4)
v_mfma_f32_32x32x16_bf16 v[64:79], a[0:3], a[96:99], v[64:79]
ds_read_b64_tr_b16 a[112:113], v23 offset:12288
ds_read_b64_tr_b16 a[114:115], v23 offset:13312
ds_read_b64_tr_b16 a[116:117], v24 offset:12288
ds_read_b64_tr_b16 a[118:119], v24 offset:13312
buffer_load_dwordx4 v7, s[64:67], s12 offen offset:3072 lds
v_mfma_f32_32x32x16_bf16 v[80:95], a[0:3], a[100:103], v[80:95]
s_mul_i32 s13, s3, 4608
s_add_u32 m0, s13, 135168
s_add_u32 s12, s88, 16384
buffer_load_dwordx4 v150, s[48:51], s88 offen lds
v_mfma_f32_32x32x16_bf16 v[96:111], a[4:7], a[96:99], v[96:111]
s_add_u32 m0, s13, 136192
s_nop 0
buffer_load_dwordx4 v150, s[48:51], s12 offen lds
v_mfma_f32_32x32x16_bf16 v[112:127], a[4:7], a[100:103], v[112:127]
buffer_load_dwordx4 a[48:51], v31, s[76:79], s42 offen offset:256 sc1
s_waitcnt vmcnt(19) lgkmcnt(4)
v_mfma_f32_32x32x16_bf16 v[64:79], a[8:11], a[104:107], v[64:79]
ds_read_b64_tr_b16 a[120:121], v23 offset:14336
ds_read_b64_tr_b16 a[122:123], v23 offset:15360
ds_read_b64_tr_b16 a[124:125], v24 offset:14336
ds_read_b64_tr_b16 a[126:127], v24 offset:15360
buffer_load_dwordx4 a[52:55], v31, s[76:79], s43 offen offset:256 sc1
v_mfma_f32_32x32x16_bf16 v[80:95], a[8:11], a[108:111], v[80:95]
buffer_load_dwordx4 a[56:59], v31, s[76:79], s42 offen offset:384 sc1
v_mfma_f32_32x32x16_bf16 v[96:111], a[12:15], a[104:107], v[96:111]
buffer_load_dwordx4 a[60:63], v31, s[76:79], s43 offen offset:384 sc1
v_mfma_f32_32x32x16_bf16 v[112:127], a[12:15], a[108:111], v[112:127]
s_waitcnt vmcnt(20) lgkmcnt(4)
v_mfma_f32_32x32x16_bf16 v[64:79], a[16:19], a[112:115], v[64:79]
ds_read_b64_tr_b16 a[96:97], v23 offset:0
ds_read_b64_tr_b16 a[98:99], v23 offset:1024
ds_read_b64_tr_b16 a[100:101], v24 offset:0
ds_read_b64_tr_b16 a[102:103], v24 offset:1024
s_mul_i32 s43, s39, 8192
s_add_u32 s42, s43, s91
s_add_u32 s43, s43, s89
buffer_load_dwordx4 a[64:67], v31, s[76:79], s42 offen offset:0 sc1
s_waitcnt vmcnt(13)
v_cvt_pk_bf16_f32 v28, v28, v28
v_lshlrev_b32 v28, 16, v28
v_mfma_f32_32x32x16_bf16 v[80:95], a[16:19], a[116:119], v[80:95]
buffer_load_dwordx4 a[68:71], v31, s[76:79], s43 offen offset:0 sc1
v_mul_f32 v28, 0xbfb8aa3b, v28
v_exp_f32 v28, v28
s_nop 0
v_add_f32 v28, 1.0, v28
v_mfma_f32_32x32x16_bf16 v[96:111], a[20:23], a[112:115], v[96:111]
v_rcp_f32 v28, v28
s_nop 0
v_cvt_pk_bf16_f32 v28, v28, v28
v_lshlrev_b32 v28, 16, v28
v_mfma_f32_32x32x16_bf16 v[112:127], a[20:23], a[116:119], v[112:127]
v_sub_f32 v142, 1.0, v28
v_cvt_pk_bf16_f32 v142, v142, v142
v_lshlrev_b32 v142, 16, v142
s_waitcnt lgkmcnt(4)
v_mfma_f32_32x32x16_bf16 v[64:79], a[24:27], a[120:123], v[64:79]
ds_read_b64_tr_b16 a[104:105], v23 offset:2048
ds_read_b64_tr_b16 a[106:107], v23 offset:3072
ds_read_b64_tr_b16 a[108:109], v24 offset:2048
ds_read_b64_tr_b16 a[110:111], v24 offset:3072
s_add_u32 m0, s46, 32768
s_lshl_b32 s12, s47, 16
s_lshl_b32 s13, s7, 7
s_add_u32 s12, s12, s13
buffer_load_dwordx4 v4, s[64:67], s12 offen offset:0 lds
v_max_f32 v28, 0x21800000, v28
v_rcp_f32 v145, v28
s_lshl_b32 s94, s3, 9
s_add_u32 s94, s94, 153600
v_lshl_add_u32 v146, v0, 2, s94
v_mfma_f32_32x32x16_bf16 v[80:95], a[24:27], a[124:127], v[80:95]
buffer_load_dwordx4 v5, s[64:67], s12 offen offset:1024 lds
v_mul_f32 v142, v142, v145
ds_write_b32 v146, v142
ds_write_b32 v146, v28 offset:256
s_lshr_b32 s95, s3, 1
s_lshl_b32 s95, s95, 7
s_add_u32 s94, s94, s95
v_lshrrev_b32 v143, 5, v0
v_mfma_f32_32x32x16_bf16 v[96:111], a[28:31], a[120:123], v[96:111]
buffer_load_dwordx4 v6, s[64:67], s12 offen offset:2048 lds
v_lshl_add_u32 v143, v143, 6, s94
v_xor_b32 v144, 128, v143
s_waitcnt lgkmcnt(0)
ds_read_b128 v[32:35], v143 offset:0
ds_read_b128 v[36:39], v143 offset:16
ds_read_b128 v[40:43], v143 offset:32
ds_read_b128 v[44:47], v143 offset:48
v_mfma_f32_32x32x16_bf16 v[112:127], a[28:31], a[124:127], v[112:127]
buffer_load_dwordx4 v7, s[64:67], s12 offen offset:3072 lds
ds_read_b128 v[48:51], v144 offset:0
ds_read_b128 v[52:55], v144 offset:16
ds_read_b128 v[56:59], v144 offset:32
ds_read_b128 v[60:63], v144 offset:48
ds_read_b128 v[224:227], v143 offset:256
ds_read_b128 v[228:231], v143 offset:272
ds_read_b128 v[232:235], v143 offset:288
ds_read_b128 v[236:239], v143 offset:304
v_mfma_f32_32x32x16_bf16 v[64:79], a[32:35], a[96:99], v[64:79]
ds_read_b64_tr_b16 a[112:113], v23 offset:4096
ds_read_b64_tr_b16 a[114:115], v23 offset:5120
ds_read_b64_tr_b16 a[116:117], v24 offset:4096
ds_read_b64_tr_b16 a[118:119], v24 offset:5120
s_add_u32 m0, s46, 36864
s_add_u32 s12, s12, 32768
buffer_load_dwordx4 v4, s[64:67], s12 offen offset:0 lds
v_mfma_f32_32x32x16_bf16 v[80:95], a[32:35], a[100:103], v[80:95]
buffer_load_dwordx4 v5, s[64:67], s12 offen offset:1024 lds
v_mfma_f32_32x32x16_bf16 v[96:111], a[36:39], a[96:99], v[96:111]
buffer_load_dwordx4 v6, s[64:67], s12 offen offset:2048 lds
v_mfma_f32_32x32x16_bf16 v[112:127], a[36:39], a[100:103], v[112:127]
buffer_load_dwordx4 v7, s[64:67], s12 offen offset:3072 lds
v_mfma_f32_32x32x16_bf16 v[64:79], a[40:43], a[104:107], v[64:79]
ds_read_b64_tr_b16 a[120:121], v23 offset:6144
ds_read_b64_tr_b16 a[122:123], v23 offset:7168
ds_read_b64_tr_b16 a[124:125], v24 offset:6144
ds_read_b64_tr_b16 a[126:127], v24 offset:7168
buffer_load_dwordx4 a[72:75], v31, s[76:79], s42 offen offset:128 sc1
v_mfma_f32_32x32x16_bf16 v[80:95], a[40:43], a[108:111], v[80:95]
buffer_load_dwordx4 a[76:79], v31, s[76:79], s43 offen offset:128 sc1
v_mfma_f32_32x32x16_bf16 v[96:111], a[44:47], a[104:107], v[96:111]
buffer_load_dwordx4 a[80:83], v31, s[76:79], s42 offen offset:256 sc1
v_mfma_f32_32x32x16_bf16 v[112:127], a[44:47], a[108:111], v[112:127]
buffer_load_dwordx4 a[84:87], v31, s[76:79], s43 offen offset:256 sc1
s_add_u32 s60, s45, 0xd40000
s_load_dwordx8 s[52:59], s[76:77], s60 glc
s_waitcnt vmcnt(16) lgkmcnt(4)
v_mfma_f32_32x32x16_bf16 v[64:79], a[48:51], a[112:115], v[64:79]
ds_read_b64_tr_b16 a[96:97], v29 offset:0
ds_read_b64_tr_b16 a[98:99], v29 offset:1024
ds_read_b64_tr_b16 a[100:101], v30 offset:0
ds_read_b64_tr_b16 a[102:103], v30 offset:1024
buffer_load_dwordx4 a[88:91], v31, s[76:79], s42 offen offset:384 sc1
v_mfma_f32_32x32x16_bf16 v[80:95], a[48:51], a[116:119], v[80:95]
buffer_load_dwordx4 a[92:95], v31, s[76:79], s43 offen offset:384 sc1
v_mfma_f32_32x32x16_bf16 v[96:111], a[52:55], a[112:115], v[96:111]
s_mul_i32 s43, s47, 8192
s_add_u32 s42, s43, s91
s_add_u32 s43, s43, s89
buffer_load_dwordx4 a[0:3], v31, s[76:79], s42 offen offset:0 sc1
v_mfma_f32_32x32x16_bf16 v[112:127], a[52:55], a[116:119], v[112:127]
buffer_load_dwordx4 a[4:7], v31, s[76:79], s43 offen offset:0 sc1
s_waitcnt vmcnt(18) lgkmcnt(4)
v_mfma_f32_32x32x16_bf16 v[64:79], a[56:59], a[120:123], v[64:79]
ds_read_b64_tr_b16 a[104:105], v29 offset:2048
ds_read_b64_tr_b16 a[106:107], v29 offset:3072
ds_read_b64_tr_b16 a[108:109], v30 offset:2048
ds_read_b64_tr_b16 a[110:111], v30 offset:3072
v_lshrrev_b32 v11, 3, v0
v_lshlrev_b32 v11, 10, v11
v_lshrrev_b32 v10, 4, v0
v_and_b32 v9, 7, v0
v_xor_b32 v10, v10, v9
v_lshl_add_u32 v8, v10, 4, v11
v_xor_b32 v9, 64, v8
v_add_u32 v9, 7168, v9
v_add_u32 v10, 14336, v8
v_add_u32 v11, 14336, v9
s_add_u32 m0, s90, 73728
s_bitcmp1_b32 s18, 0
s_cselect_b32 s24, s72, s68
s_cselect_b32 s25, s73, s69
s_and_b32 s13, s18, 2
s_lshl_b32 s12, s3, 2
s_add_u32 s12, s12, s13
s_lshl_b32 s12, s12, 6
s_lshl_b32 s13, s7, 16
s_add_u32 s12, s12, s13
s_mov_b32 s26, s70
buffer_load_dwordx4 v8, s[24:27], s12 offen offset:0 lds
v_mfma_f32_32x32x16_bf16 v[80:95], a[56:59], a[124:127], v[80:95]
buffer_load_dwordx4 v9, s[24:27], s12 offen offset:1024 lds
v_mfma_f32_32x32x16_bf16 v[96:111], a[60:63], a[120:123], v[96:111]
buffer_load_dwordx4 v10, s[24:27], s12 offen offset:2048 lds
v_mfma_f32_32x32x16_bf16 v[112:127], a[60:63], a[124:127], v[112:127]
buffer_load_dwordx4 v11, s[24:27], s12 offen offset:3072 lds
s_waitcnt lgkmcnt(0)
s_and_b64 s[62:63], s[52:53], s[54:55]
s_or_b64 s[52:53], s[52:53], s[54:55]
s_and_b64 s[54:55], s[56:57], s[58:59]
s_or_b64 s[56:57], s[56:57], s[58:59]
s_and_b64 s[62:63], s[62:63], s[54:55]
s_or_b64 s[52:53], s[52:53], s[56:57]
s_and_b32 s62, s62, s63
s_or_b32 s52, s52, s53
s_xor_b32 s62, s62, s10
s_xor_b32 s52, s52, s10
s_or_b32 s52, s52, s62
s_cbranch_scc0 L_fs_ok
s_mov_b32 s98, 20000
L_fs_loop:
s_load_dwordx8 s[52:59], s[76:77], s60 glc
s_waitcnt lgkmcnt(0)
s_and_b64 s[62:63], s[52:53], s[54:55]
s_or_b64 s[52:53], s[52:53], s[54:55]
s_and_b64 s[54:55], s[56:57], s[58:59]
s_or_b64 s[56:57], s[56:57], s[58:59]
s_and_b64 s[62:63], s[62:63], s[54:55]
s_or_b64 s[52:53], s[52:53], s[56:57]
s_and_b32 s62, s62, s63
s_or_b32 s52, s52, s53
s_xor_b32 s62, s62, s10
s_xor_b32 s52, s52, s10
s_or_b32 s52, s52, s62
s_cbranch_scc0 L_fs_ok
s_sub_u32 s98, s98, 1
s_cmp_lg_u32 s98, 0
s_cbranch_scc1 L_fs_loop
L_fs_ok:
buffer_load_dwordx4 a[8:11], v31, s[76:79], s42 offen offset:128 sc1
buffer_load_dwordx4 a[12:15], v31, s[76:79], s43 offen offset:128 sc1
buffer_load_dwordx4 a[16:19], v31, s[76:79], s42 offen offset:256 sc1
buffer_load_dwordx4 a[20:23], v31, s[76:79], s43 offen offset:256 sc1
s_waitcnt vmcnt(24)
v_mfma_f32_32x32x16_bf16 v[64:79], a[64:67], a[96:99], v[64:79]
ds_read_b64_tr_b16 a[112:113], v29 offset:4096
ds_read_b64_tr_b16 a[114:115], v29 offset:5120
ds_read_b64_tr_b16 a[116:117], v30 offset:4096
ds_read_b64_tr_b16 a[118:119], v30 offset:5120
s_add_u32 m0, s90, 77824
s_add_u32 s12, s12, 32768
buffer_load_dwordx4 v8, s[24:27], s12 offen offset:0 lds
v_mfma_f32_32x32x16_bf16 v[80:95], a[64:67], a[100:103], v[80:95]
buffer_load_dwordx4 v9, s[24:27], s12 offen offset:1024 lds
v_mfma_f32_32x32x16_bf16 v[96:111], a[68:71], a[96:99], v[96:111]
buffer_load_dwordx4 v10, s[24:27], s12 offen offset:2048 lds
v_mfma_f32_32x32x16_bf16 v[112:127], a[68:71], a[100:103], v[112:127]
buffer_load_dwordx4 v11, s[24:27], s12 offen offset:3072 lds
s_waitcnt vmcnt(18)
v_mfma_f32_32x32x16_bf16 v[64:79], a[72:75], a[104:107], v[64:79]
ds_read_b64_tr_b16 a[120:121], v29 offset:6144
ds_read_b64_tr_b16 a[122:123], v29 offset:7168
ds_read_b64_tr_b16 a[124:125], v30 offset:6144
ds_read_b64_tr_b16 a[126:127], v30 offset:7168
buffer_load_dwordx4 a[24:27], v31, s[76:79], s42 offen offset:384 sc1
v_mfma_f32_32x32x16_bf16 v[80:95], a[72:75], a[108:111], v[80:95]
buffer_load_dwordx4 a[28:31], v31, s[76:79], s43 offen offset:384 sc1
v_mfma_f32_32x32x16_bf16 v[96:111], a[76:79], a[104:107], v[96:111]
v_mfma_f32_32x32x16_bf16 v[112:127], a[76:79], a[108:111], v[112:127]
s_waitcnt vmcnt(18) lgkmcnt(4)
v_mfma_f32_32x32x16_bf16 v[64:79], a[80:83], a[112:115], v[64:79]
ds_read_b64_tr_b16 a[96:97], v29 offset:32768
ds_read_b64_tr_b16 a[98:99], v29 offset:33792
ds_read_b64_tr_b16 a[100:101], v30 offset:32768
ds_read_b64_tr_b16 a[102:103], v30 offset:33792
s_lshl_b32 s43, s3, 2
s_add_u32 s43, s43, s18
s_add_u32 s43, s43, 28
s_mul_i32 s43, s43, 8192
s_add_u32 s42, s43, s91
s_add_u32 s43, s43, s89
buffer_load_dwordx4 a[32:35], v31, s[76:79], s42 offen offset:0 sc1
v_mfma_f32_32x32x16_bf16 v[80:95], a[80:83], a[116:119], v[80:95]
buffer_load_dwordx4 a[36:39], v31, s[76:79], s43 offen offset:0 sc1
v_mfma_f32_32x32x16_bf16 v[96:111], a[84:87], a[112:115], v[96:111]
v_mfma_f32_32x32x16_bf16 v[112:127], a[84:87], a[116:119], v[112:127]
s_waitcnt vmcnt(18) lgkmcnt(4)
v_mfma_f32_32x32x16_bf16 v[64:79], a[88:91], a[120:123], v[64:79]
ds_read_b64_tr_b16 a[104:105], v29 offset:34816
ds_read_b64_tr_b16 a[106:107], v29 offset:35840
ds_read_b64_tr_b16 a[108:109], v30 offset:34816
ds_read_b64_tr_b16 a[110:111], v30 offset:35840
s_add_u32 m0, s90, 65536
s_bitcmp1_b32 s19, 0
s_cselect_b32 s24, s72, s68
s_cselect_b32 s25, s73, s69
s_and_b32 s13, s19, 2
s_lshl_b32 s12, s3, 2
s_add_u32 s12, s12, s13
s_lshl_b32 s12, s12, 6
s_lshl_b32 s13, s7, 16
s_add_u32 s12, s12, s13
buffer_load_dwordx4 v8, s[24:27], s12 offen offset:0 lds
v_mfma_f32_32x32x16_bf16 v[80:95], a[88:91], a[124:127], v[80:95]
buffer_load_dwordx4 v9, s[24:27], s12 offen offset:1024 lds
v_mfma_f32_32x32x16_bf16 v[96:111], a[92:95], a[120:123], v[96:111]
buffer_load_dwordx4 v10, s[24:27], s12 offen offset:2048 lds
v_mfma_f32_32x32x16_bf16 v[112:127], a[92:95], a[124:127], v[112:127]
buffer_load_dwordx4 v11, s[24:27], s12 offen offset:3072 lds
s_waitcnt vmcnt(20) lgkmcnt(4)
v_mfma_f32_32x32x16_bf16 v[64:79], a[0:3], a[96:99], v[64:79]
ds_read_b64_tr_b16 a[112:113], v29 offset:36864
ds_read_b64_tr_b16 a[114:115], v29 offset:37888
ds_read_b64_tr_b16 a[116:117], v30 offset:36864
ds_read_b64_tr_b16 a[118:119], v30 offset:37888
s_add_u32 m0, s90, 69632
s_add_u32 s12, s12, 32768
buffer_load_dwordx4 v8, s[24:27], s12 offen offset:0 lds
ds_read_u16 v192, v151 offset:0
ds_read_u16 v193, v151 offset:64
ds_read_u16 v194, v151 offset:128
ds_read_u16 v195, v151 offset:192
ds_read_u16 v196, v151 offset:256
ds_read_u16 v197, v151 offset:320
ds_read_u16 v198, v151 offset:384
ds_read_u16 v199, v151 offset:448
ds_read_u16 v200, v151 offset:512
ds_read_u16 v201, v151 offset:576
ds_read_u16 v202, v151 offset:640
ds_read_u16 v203, v151 offset:704
v_mfma_f32_32x32x16_bf16 v[80:95], a[0:3], a[100:103], v[80:95]
buffer_load_dwordx4 v9, s[24:27], s12 offen offset:1024 lds
ds_read_u16 v204, v151 offset:768
ds_read_u16 v205, v151 offset:832
ds_read_u16 v206, v151 offset:896
ds_read_u16 v207, v151 offset:960
v_mfma_f32_32x32x16_bf16 v[96:111], a[4:7], a[96:99], v[96:111]
buffer_load_dwordx4 v10, s[24:27], s12 offen offset:2048 lds
v_mfma_f32_32x32x16_bf16 v[112:127], a[4:7], a[100:103], v[112:127]
buffer_load_dwordx4 v11, s[24:27], s12 offen offset:3072 lds
s_waitcnt vmcnt(18) lgkmcnt(15)
v_mfma_f32_32x32x16_bf16 v[64:79], a[8:11], a[104:107], v[64:79]
ds_read_b64_tr_b16 a[120:121], v29 offset:38912
ds_read_b64_tr_b16 a[122:123], v29 offset:39936
ds_read_b64_tr_b16 a[124:125], v30 offset:38912
ds_read_b64_tr_b16 a[126:127], v30 offset:39936
buffer_load_dwordx4 a[40:43], v31, s[76:79], s42 offen offset:128 sc1
v_mfma_f32_32x32x16_bf16 v[80:95], a[8:11], a[108:111], v[80:95]
buffer_load_dwordx4 a[44:47], v31, s[76:79], s43 offen offset:128 sc1
v_mfma_f32_32x32x16_bf16 v[96:111], a[12:15], a[104:107], v[96:111]
buffer_load_dwordx4 a[48:51], v31, s[76:79], s42 offen offset:256 sc1
v_mfma_f32_32x32x16_bf16 v[112:127], a[12:15], a[108:111], v[112:127]
buffer_load_dwordx4 a[52:55], v31, s[76:79], s43 offen offset:256 sc1
s_waitcnt vmcnt(20)
v_mfma_f32_32x32x16_bf16 v[64:79], a[16:19], a[112:115], v[64:79]
s_waitcnt vmcnt(16)
ds_read_b128 a[96:99], v216 offset:8192
ds_read_b128 a[100:103], v220 offset:8192
buffer_load_dwordx4 a[56:59], v31, s[76:79], s42 offen offset:384 sc1
v_mfma_f32_32x32x16_bf16 v[80:95], a[16:19], a[116:119], v[80:95]
buffer_load_dwordx4 a[60:63], v31, s[76:79], s43 offen offset:384 sc1
v_mfma_f32_32x32x16_bf16 v[96:111], a[20:23], a[112:115], v[96:111]
s_lshl_b32 s43, s3, 2
s_add_u32 s43, s43, s19
s_add_u32 s43, s43, 28
s_mul_i32 s43, s43, 8192
s_add_u32 s42, s43, s91
s_add_u32 s43, s43, s89
buffer_load_dwordx4 a[64:67], v31, s[76:79], s42 offen offset:0 sc1
v_mfma_f32_32x32x16_bf16 v[112:127], a[20:23], a[116:119], v[112:127]
buffer_load_dwordx4 a[68:71], v31, s[76:79], s43 offen offset:0 sc1
s_waitcnt vmcnt(18) lgkmcnt(2)
v_mfma_f32_32x32x16_bf16 v[64:79], a[24:27], a[120:123], v[64:79]
ds_read_b128 a[104:107], v217 offset:8192
ds_read_b128 a[108:111], v221 offset:8192
s_add_u32 m0, s46, 0
s_bitcmp1_b32 s40, 0
s_cselect_b32 s24, s72, s68
s_cselect_b32 s25, s73, s69
s_and_b32 s13, s40, 2
s_lshl_b32 s12, s3, 2
s_add_u32 s12, s12, s13
s_lshl_b32 s12, s12, 6
s_lshl_b32 s13, s7, 16
s_add_u32 s12, s12, s13
buffer_load_dwordx4 v8, s[24:27], s12 offen offset:0 lds
v_mfma_f32_32x32x16_bf16 v[80:95], a[24:27], a[124:127], v[80:95]
buffer_load_dwordx4 v9, s[24:27], s12 offen offset:1024 lds
v_mfma_f32_32x32x16_bf16 v[96:111], a[28:31], a[120:123], v[96:111]
buffer_load_dwordx4 v10, s[24:27], s12 offen offset:2048 lds
v_mfma_f32_32x32x16_bf16 v[112:127], a[28:31], a[124:127], v[112:127]
buffer_load_dwordx4 v11, s[24:27], s12 offen offset:3072 lds
v_mul_f32 v64, v64, v32
v_mul_f32 v65, v65, v33
v_mul_f32 v66, v66, v34
v_mul_f32 v67, v67, v35
v_mul_f32 v68, v68, v36
v_mul_f32 v69, v69, v37
v_mul_f32 v70, v70, v38
v_mul_f32 v71, v71, v39
v_mul_f32 v72, v72, v40
v_mul_f32 v73, v73, v41
v_mul_f32 v74, v74, v42
v_mul_f32 v75, v75, v43
v_mul_f32 v76, v76, v44
v_mul_f32 v77, v77, v45
v_mul_f32 v78, v78, v46
v_mul_f32 v79, v79, v47
s_add_u32 m0, s46, 4096
s_add_u32 s12, s12, 32768
buffer_load_dwordx4 v8, s[24:27], s12 offen offset:0 lds
buffer_load_dwordx4 v9, s[24:27], s12 offen offset:1024 lds
v_mul_f32 v80, v80, v32
v_mul_f32 v81, v81, v33
v_mul_f32 v82, v82, v34
v_mul_f32 v83, v83, v35
v_mul_f32 v84, v84, v36
v_mul_f32 v85, v85, v37
v_mul_f32 v86, v86, v38
v_mul_f32 v87, v87, v39
v_mul_f32 v88, v88, v40
v_mul_f32 v89, v89, v41
v_mul_f32 v90, v90, v42
v_mul_f32 v91, v91, v43
v_mul_f32 v92, v92, v44
v_mul_f32 v93, v93, v45
v_mul_f32 v94, v94, v46
v_mul_f32 v95, v95, v47
buffer_load_dwordx4 v10, s[24:27], s12 offen offset:2048 lds
buffer_load_dwordx4 v11, s[24:27], s12 offen offset:3072 lds
v_mul_f32 v96, v96, v48
v_mul_f32 v97, v97, v49
v_mul_f32 v98, v98, v50
v_mul_f32 v99, v99, v51
v_mul_f32 v100, v100, v52
v_mul_f32 v101, v101, v53
v_mul_f32 v102, v102, v54
v_mul_f32 v103, v103, v55
v_mul_f32 v104, v104, v56
v_mul_f32 v105, v105, v57
v_mul_f32 v106, v106, v58
v_mul_f32 v107, v107, v59
v_mul_f32 v108, v108, v60
v_mul_f32 v109, v109, v61
v_mul_f32 v110, v110, v62
v_mul_f32 v111, v111, v63
buffer_load_dwordx4 a[72:75], v31, s[76:79], s42 offen offset:128 sc1
buffer_load_dwordx4 a[76:79], v31, s[76:79], s43 offen offset:128 sc1
v_mul_f32 v112, v112, v48
v_mul_f32 v113, v113, v49
v_mul_f32 v114, v114, v50
v_mul_f32 v115, v115, v51
v_mul_f32 v116, v116, v52
v_mul_f32 v117, v117, v53
v_mul_f32 v118, v118, v54
v_mul_f32 v119, v119, v55
v_mul_f32 v120, v120, v56
v_mul_f32 v121, v121, v57
v_mul_f32 v122, v122, v58
v_mul_f32 v123, v123, v59
v_mul_f32 v124, v124, v60
v_mul_f32 v125, v125, v61
v_mul_f32 v126, v126, v62
v_mul_f32 v127, v127, v63
buffer_load_dwordx4 a[80:83], v31, s[76:79], s42 offen offset:256 sc1
buffer_load_dwordx4 a[84:87], v31, s[76:79], s43 offen offset:256 sc1
v_dot2c_f32_bf16 v64, v192, v152
v_dot2c_f32_bf16 v65, v193, v152
v_dot2c_f32_bf16 v66, v194, v152
v_dot2c_f32_bf16 v67, v195, v152
v_dot2c_f32_bf16 v68, v196, v152
v_dot2c_f32_bf16 v69, v197, v152
v_dot2c_f32_bf16 v70, v198, v152
v_dot2c_f32_bf16 v71, v199, v152
v_dot2c_f32_bf16 v72, v200, v152
v_dot2c_f32_bf16 v73, v201, v152
v_dot2c_f32_bf16 v74, v202, v152
v_dot2c_f32_bf16 v75, v203, v152
v_dot2c_f32_bf16 v76, v204, v152
v_dot2c_f32_bf16 v77, v205, v152
v_dot2c_f32_bf16 v78, v206, v152
v_dot2c_f32_bf16 v79, v207, v152
s_waitcnt vmcnt(28) lgkmcnt(2)
v_mfma_f32_32x32x16_bf16 v[112:127], a[36:39], a[100:103], v[112:127]
v_mfma_f32_32x32x16_bf16 v[96:111], a[36:39], a[96:99], v[96:111]
v_mfma_f32_32x32x16_bf16 v[80:95], a[32:35], a[100:103], v[80:95]
v_mfma_f32_32x32x16_bf16 v[64:79], a[32:35], a[96:99], v[64:79]
ds_read_b128 a[112:115], v218 offset:8192
ds_read_b128 a[116:119], v222 offset:8192
s_waitcnt vmcnt(18) lgkmcnt(2)
v_mfma_f32_32x32x16_bf16 v[64:79], a[40:43], a[104:107], v[64:79]
ds_read_b128 a[120:123], v219 offset:8192
ds_read_b128 a[124:127], v223 offset:8192
buffer_load_dwordx4 a[88:91], v31, s[76:79], s42 offen offset:384 sc1
v_mfma_f32_32x32x16_bf16 v[80:95], a[40:43], a[108:111], v[80:95]
buffer_load_dwordx4 a[92:95], v31, s[76:79], s43 offen offset:384 sc1
v_mfma_f32_32x32x16_bf16 v[96:111], a[44:47], a[104:107], v[96:111]
v_mfma_f32_32x32x16_bf16 v[112:127], a[44:47], a[108:111], v[112:127]
s_waitcnt vmcnt(18) lgkmcnt(2)
v_mfma_f32_32x32x16_bf16 v[64:79], a[48:51], a[112:115], v[64:79]
ds_read_b128 a[96:99], v216 offset:0
ds_read_b128 a[100:103], v220 offset:0
s_lshl_b32 s43, s3, 2
s_add_u32 s43, s43, s40
s_add_u32 s43, s43, 28
s_mul_i32 s43, s43, 8192
s_add_u32 s42, s43, s91
s_add_u32 s43, s43, s89
buffer_load_dwordx4 a[0:3], v31, s[76:79], s42 offen offset:0 sc1
v_mfma_f32_32x32x16_bf16 v[80:95], a[48:51], a[116:119], v[80:95]
buffer_load_dwordx4 a[4:7], v31, s[76:79], s43 offen offset:0 sc1
v_mfma_f32_32x32x16_bf16 v[96:111], a[52:55], a[112:115], v[96:111]
v_mfma_f32_32x32x16_bf16 v[112:127], a[52:55], a[116:119], v[112:127]
s_waitcnt vmcnt(18) lgkmcnt(2)
v_mfma_f32_32x32x16_bf16 v[64:79], a[56:59], a[120:123], v[64:79]
ds_read_b128 a[104:107], v217 offset:0
ds_read_b128 a[108:111], v221 offset:0
s_add_u32 m0, s46, 32768
s_bitcmp1_b32 s41, 0
s_cselect_b32 s24, s72, s68
s_cselect_b32 s25, s73, s69
s_and_b32 s13, s41, 2
s_lshl_b32 s12, s3, 2
s_add_u32 s12, s12, s13
s_lshl_b32 s12, s12, 6
s_lshl_b32 s13, s7, 16
s_add_u32 s12, s12, s13
buffer_load_dwordx4 v8, s[24:27], s12 offen offset:0 lds
v_mfma_f32_32x32x16_bf16 v[80:95], a[56:59], a[124:127], v[80:95]
buffer_load_dwordx4 v9, s[24:27], s12 offen offset:1024 lds
v_mfma_f32_32x32x16_bf16 v[96:111], a[60:63], a[120:123], v[96:111]
buffer_load_dwordx4 v10, s[24:27], s12 offen offset:2048 lds
v_mfma_f32_32x32x16_bf16 v[112:127], a[60:63], a[124:127], v[112:127]
buffer_load_dwordx4 v11, s[24:27], s12 offen offset:3072 lds
s_waitcnt vmcnt(20) lgkmcnt(2)
v_mfma_f32_32x32x16_bf16 v[64:79], a[64:67], a[96:99], v[64:79]
ds_read_b128 a[112:115], v218 offset:0
ds_read_b128 a[116:119], v222 offset:0
s_add_u32 m0, s46, 36864
s_add_u32 s12, s12, 32768
buffer_load_dwordx4 v8, s[24:27], s12 offen offset:0 lds
v_mfma_f32_32x32x16_bf16 v[80:95], a[64:67], a[100:103], v[80:95]
buffer_load_dwordx4 v9, s[24:27], s12 offen offset:1024 lds
v_mfma_f32_32x32x16_bf16 v[96:111], a[68:71], a[96:99], v[96:111]
buffer_load_dwordx4 v10, s[24:27], s12 offen offset:2048 lds
v_mfma_f32_32x32x16_bf16 v[112:127], a[68:71], a[100:103], v[112:127]
buffer_load_dwordx4 v11, s[24:27], s12 offen offset:3072 lds
s_waitcnt vmcnt(14) lgkmcnt(2)
v_mfma_f32_32x32x16_bf16 v[64:79], a[72:75], a[104:107], v[64:79]
ds_read_b128 a[120:123], v219 offset:0
ds_read_b128 a[124:127], v223 offset:0
buffer_load_dwordx4 a[8:11], v31, s[76:79], s42 offen offset:128 sc1
v_mfma_f32_32x32x16_bf16 v[80:95], a[72:75], a[108:111], v[80:95]
buffer_load_dwordx4 a[12:15], v31, s[76:79], s43 offen offset:128 sc1
v_mfma_f32_32x32x16_bf16 v[96:111], a[76:79], a[104:107], v[96:111]
buffer_load_dwordx4 a[16:19], v31, s[76:79], s42 offen offset:256 sc1
v_mfma_f32_32x32x16_bf16 v[112:127], a[76:79], a[108:111], v[112:127]
buffer_load_dwordx4 a[20:23], v31, s[76:79], s43 offen offset:256 sc1
s_waitcnt vmcnt(16) lgkmcnt(2)
v_mfma_f32_32x32x16_bf16 v[64:79], a[80:83], a[112:115], v[64:79]
ds_read_b128 a[96:99], v208 offset:0
ds_read_b128 a[100:103], v212 offset:0
buffer_load_dwordx4 a[24:27], v31, s[76:79], s42 offen offset:384 sc1
v_mfma_f32_32x32x16_bf16 v[80:95], a[80:83], a[116:119], v[80:95]
buffer_load_dwordx4 a[28:31], v31, s[76:79], s43 offen offset:384 sc1
v_mfma_f32_32x32x16_bf16 v[96:111], a[84:87], a[112:115], v[96:111]
s_lshl_b32 s43, s3, 2
s_add_u32 s43, s43, s41
s_add_u32 s43, s43, 28
s_mul_i32 s43, s43, 8192
s_add_u32 s42, s43, s91
s_add_u32 s43, s43, s89
buffer_load_dwordx4 a[32:35], v31, s[76:79], s42 offen offset:0 sc1
v_mfma_f32_32x32x16_bf16 v[112:127], a[84:87], a[116:119], v[112:127]
buffer_load_dwordx4 a[36:39], v31, s[76:79], s43 offen offset:0 sc1
s_waitcnt vmcnt(18) lgkmcnt(2)
v_mfma_f32_32x32x16_bf16 v[64:79], a[88:91], a[120:123], v[64:79]
ds_read_b128 a[104:107], v209 offset:0
ds_read_b128 a[108:111], v213 offset:0
buffer_load_dwordx4 a[40:43], v31, s[76:79], s42 offen offset:128 sc1
v_mfma_f32_32x32x16_bf16 v[80:95], a[88:91], a[124:127], v[80:95]
buffer_load_dwordx4 a[44:47], v31, s[76:79], s43 offen offset:128 sc1
v_mfma_f32_32x32x16_bf16 v[96:111], a[92:95], a[120:123], v[96:111]
v_mfma_f32_32x32x16_bf16 v[112:127], a[92:95], a[124:127], v[112:127]
s_waitcnt vmcnt(18) lgkmcnt(2)
v_mfma_f32_32x32x16_bf16 v[64:79], a[0:3], a[96:99], v[64:79]
ds_read_b128 a[112:115], v210 offset:0
ds_read_b128 a[116:119], v214 offset:0
buffer_load_dwordx4 a[48:51], v31, s[76:79], s42 offen offset:256 sc1
v_mfma_f32_32x32x16_bf16 v[80:95], a[0:3], a[100:103], v[80:95]
buffer_load_dwordx4 a[52:55], v31, s[76:79], s43 offen offset:256 sc1
v_mfma_f32_32x32x16_bf16 v[96:111], a[4:7], a[96:99], v[96:111]
v_mfma_f32_32x32x16_bf16 v[112:127], a[4:7], a[100:103], v[112:127]
s_waitcnt vmcnt(10) lgkmcnt(2)
v_mfma_f32_32x32x16_bf16 v[64:79], a[8:11], a[104:107], v[64:79]
ds_read_b128 a[120:123], v211 offset:0
ds_read_b128 a[124:127], v215 offset:0
buffer_load_dwordx4 a[56:59], v31, s[76:79], s42 offen offset:384 sc1
v_mfma_f32_32x32x16_bf16 v[80:95], a[8:11], a[108:111], v[80:95]
buffer_load_dwordx4 a[60:63], v31, s[76:79], s43 offen offset:384 sc1
v_mfma_f32_32x32x16_bf16 v[96:111], a[12:15], a[104:107], v[96:111]
v_mfma_f32_32x32x16_bf16 v[112:127], a[12:15], a[108:111], v[112:127]
s_waitcnt vmcnt(10) lgkmcnt(2)
v_mfma_f32_32x32x16_bf16 v[64:79], a[16:19], a[112:115], v[64:79]
ds_read_b128 a[96:99], v208 offset:32768
ds_read_b128 a[100:103], v212 offset:32768
v_mfma_f32_32x32x16_bf16 v[80:95], a[16:19], a[116:119], v[80:95]
v_mfma_f32_32x32x16_bf16 v[96:111], a[20:23], a[112:115], v[96:111]
v_mfma_f32_32x32x16_bf16 v[112:127], a[20:23], a[116:119], v[112:127]
ds_read_b128 a[112:115], v210 offset:32768
ds_read_b128 a[116:119], v214 offset:32768
s_waitcnt vmcnt(8) lgkmcnt(4)
v_mfma_f32_32x32x16_bf16 v[64:79], a[24:27], a[120:123], v[64:79]
ds_read_b128 a[104:107], v209 offset:32768
ds_read_b128 a[108:111], v213 offset:32768
v_mfma_f32_32x32x16_bf16 v[80:95], a[24:27], a[124:127], v[80:95]
v_mfma_f32_32x32x16_bf16 v[96:111], a[28:31], a[120:123], v[96:111]
v_mfma_f32_32x32x16_bf16 v[112:127], a[28:31], a[124:127], v[112:127]
ds_read_b128 a[120:123], v211 offset:32768
ds_read_b128 a[124:127], v215 offset:32768
s_add_u32 s92, s90, 65536
v_lshl_add_u32 v1, v0, 4, s92
v_lshl_add_u32 v8, v0, 4, s46
v_xor_b32 v3, 0x4000, v1
v_xor_b32 v4, 0x8000, v1
v_xor_b32 v5, 0x6000, v8
v_lshrrev_b32 v6, 5, v0
v_lshlrev_b32 v6, 15, v6
v_and_b32 v7, 31, v0
v_lshl_add_u32 v6, v7, 2, v6
s_lshl_b32 s88, s88, 1
s_waitcnt vmcnt(0) lgkmcnt(0)
v_mfma_f32_32x32x16_bf16 v[80:95], a[32:35], a[100:103], v[80:95]
v_mfma_f32_32x32x16_bf16 v[80:95], a[40:43], a[108:111], v[80:95]
v_mfma_f32_32x32x16_bf16 v[80:95], a[48:51], a[116:119], v[80:95]
v_mfma_f32_32x32x16_bf16 v[80:95], a[56:59], a[124:127], v[80:95]
v_mfma_f32_32x32x16_bf16 v[96:111], a[36:39], a[96:99], v[96:111]
v_mfma_f32_32x32x16_bf16 v[96:111], a[44:47], a[104:107], v[96:111]
v_mfma_f32_32x32x16_bf16 v[96:111], a[52:55], a[112:115], v[96:111]
s_nop 7
s_nop 0
ds_write_b128 v1, v[80:83] offset:0
ds_write_b128 v1, v[84:87] offset:1024
v_mfma_f32_32x32x16_bf16 v[96:111], a[60:63], a[120:123], v[96:111]
ds_write_b128 v1, v[88:91] offset:2048
ds_write_b128 v1, v[92:95] offset:3072
v_mfma_f32_32x32x16_bf16 v[112:127], a[36:39], a[100:103], v[112:127]
v_mfma_f32_32x32x16_bf16 v[112:127], a[44:47], a[108:111], v[112:127]
v_mfma_f32_32x32x16_bf16 v[112:127], a[52:55], a[116:119], v[112:127]
s_nop 7
ds_write_b128 v1, v[96:99] offset:4096
ds_write_b128 v1, v[100:103] offset:5120
v_mfma_f32_32x32x16_bf16 v[112:127], a[60:63], a[124:127], v[112:127]
ds_write_b128 v1, v[104:107] offset:6144
ds_write_b128 v1, v[108:111] offset:7168
v_mfma_f32_32x32x16_bf16 v[64:79], a[32:35], a[96:99], v[64:79]
v_mfma_f32_32x32x16_bf16 v[64:79], a[40:43], a[104:107], v[64:79]
v_mfma_f32_32x32x16_bf16 v[64:79], a[48:51], a[112:115], v[64:79]
s_nop 7
ds_write_b128 v8, v[112:115] offset:0
ds_write_b128 v8, v[116:119] offset:1024
v_mfma_f32_32x32x16_bf16 v[64:79], a[56:59], a[120:123], v[64:79]
ds_write_b128 v8, v[120:123] offset:2048
ds_write_b128 v8, v[124:127] offset:3072
s_waitcnt lgkmcnt(0)
s_barrier
ds_read_b128 v[128:131], v3 offset:0
ds_read_b128 v[144:147], v4 offset:4096
ds_read_b128 v[160:163], v5 offset:0
ds_read_b128 v[132:135], v3 offset:1024
ds_read_b128 v[148:151], v4 offset:5120
ds_read_b128 v[164:167], v5 offset:1024
ds_read_b128 v[136:139], v3 offset:2048
ds_read_b128 v[152:155], v4 offset:6144
ds_read_b128 v[168:171], v5 offset:2048
ds_read_b128 v[140:143], v3 offset:3072
ds_read_b128 v[156:159], v4 offset:7168
ds_read_b128 v[172:175], v5 offset:3072
s_waitcnt lgkmcnt(9)
v_add_f32 v128, v128, v144
v_add_f32 v64, v64, v160
v_add_f32 v64, v64, v128
v_mul_f32 v64, v64, v224
buffer_store_dword v64, v6, s[80:83], s88 offen offset:0 sc1
v_add_f32 v129, v129, v145
v_add_f32 v65, v65, v161
v_add_f32 v65, v65, v129
v_mul_f32 v65, v65, v225
buffer_store_dword v65, v6, s[80:83], s88 offen offset:2048 sc1
v_add_f32 v130, v130, v146
v_add_f32 v66, v66, v162
v_add_f32 v66, v66, v130
v_mul_f32 v66, v66, v226
s_add_u32 s88, s88, 4096
buffer_store_dword v66, v6, s[80:83], s88 offen offset:0 sc1
v_add_f32 v131, v131, v147
v_add_f32 v67, v67, v163
v_add_f32 v67, v67, v131
v_mul_f32 v67, v67, v227
buffer_store_dword v67, v6, s[80:83], s88 offen offset:2048 sc1
s_waitcnt lgkmcnt(6)
v_add_f32 v132, v132, v148
v_add_f32 v68, v68, v164
v_add_f32 v68, v68, v132
v_mul_f32 v68, v68, v228
s_add_u32 s88, s88, 4096
buffer_store_dword v68, v6, s[80:83], s88 offen offset:0 sc1
v_add_f32 v133, v133, v149
v_add_f32 v69, v69, v165
v_add_f32 v69, v69, v133
v_mul_f32 v69, v69, v229
buffer_store_dword v69, v6, s[80:83], s88 offen offset:2048 sc1
v_add_f32 v134, v134, v150
v_add_f32 v70, v70, v166
v_add_f32 v70, v70, v134
v_mul_f32 v70, v70, v230
s_add_u32 s88, s88, 4096
buffer_store_dword v70, v6, s[80:83], s88 offen offset:0 sc1
v_add_f32 v135, v135, v151
v_add_f32 v71, v71, v167
v_add_f32 v71, v71, v135
v_mul_f32 v71, v71, v231
buffer_store_dword v71, v6, s[80:83], s88 offen offset:2048 sc1
s_waitcnt lgkmcnt(3)
v_add_f32 v136, v136, v152
v_add_f32 v72, v72, v168
v_add_f32 v72, v72, v136
v_mul_f32 v72, v72, v232
s_add_u32 s88, s88, 4096
buffer_store_dword v72, v6, s[80:83], s88 offen offset:0 sc1
v_add_f32 v137, v137, v153
v_add_f32 v73, v73, v169
v_add_f32 v73, v73, v137
v_mul_f32 v73, v73, v233
buffer_store_dword v73, v6, s[80:83], s88 offen offset:2048 sc1
v_add_f32 v138, v138, v154
v_add_f32 v74, v74, v170
v_add_f32 v74, v74, v138
v_mul_f32 v74, v74, v234
s_add_u32 s88, s88, 4096
buffer_store_dword v74, v6, s[80:83], s88 offen offset:0 sc1
v_add_f32 v139, v139, v155
v_add_f32 v75, v75, v171
v_add_f32 v75, v75, v139
v_mul_f32 v75, v75, v235
buffer_store_dword v75, v6, s[80:83], s88 offen offset:2048 sc1
s_waitcnt lgkmcnt(0)
v_add_f32 v140, v140, v156
v_add_f32 v76, v76, v172
v_add_f32 v76, v76, v140
v_mul_f32 v76, v76, v236
s_add_u32 s88, s88, 4096
buffer_store_dword v76, v6, s[80:83], s88 offen offset:0 sc1
v_add_f32 v141, v141, v157
v_add_f32 v77, v77, v173
v_add_f32 v77, v77, v141
v_mul_f32 v77, v77, v237
buffer_store_dword v77, v6, s[80:83], s88 offen offset:2048 sc1
v_add_f32 v142, v142, v158
v_add_f32 v78, v78, v174
v_add_f32 v78, v78, v142
v_mul_f32 v78, v78, v238
s_add_u32 s88, s88, 4096
buffer_store_dword v78, v6, s[80:83], s88 offen offset:0 sc1
v_add_f32 v143, v143, v159
v_add_f32 v79, v79, v175
v_add_f32 v79, v79, v143
v_mul_f32 v79, v79, v239
buffer_store_dword v79, v6, s[80:83], s88 offen offset:2048 sc1
L_end:
s_endpgm
.section .rodata,"a"
.p2align 6
.amdhsa_kernel gated_mix__ssm_conv_s5__dense_activation_relu__prompt_kernel
  .amdhsa_next_free_vgpr 512
  .amdhsa_next_free_sgpr 102
  .amdhsa_accum_offset 256
  .amdhsa_group_segment_fixed_size 0
  .amdhsa_kernarg_size 128
  .amdhsa_user_sgpr_count 2
  .amdhsa_user_sgpr_kernarg_segment_ptr 1
  .amdhsa_system_sgpr_workgroup_id_x 1
.end_amdhsa_kernel
```
